```python
import torch

def _softmax(x, axis=-1):
    return torch.softmax(x, dim=axis)
def _gelu(x):
    return torch.nn.functional.gelu(x, approximate="tanh")
def _silu(x):
    return torch.nn.functional.silu(x)
def _sigmoid(x):
    return torch.sigmoid(x)
def _layernorm(x, axis=-1, eps=1e-5):
    m = x.mean(dim=axis, keepdim=True)
    v = x.var(dim=axis, keepdim=True, unbiased=False)
    return (x - m) / torch.sqrt(v + eps)
def _scatter_add(tgt, idx, src, axis=0):
    return tgt.clone().index_add_(axis, idx, src)
def _segment_sum(src, seg, n):
    out = torch.zeros((n,) + src.shape[1:], dtype=src.dtype)
    return out.index_add_(0, seg, src)
def _pad(x, pw):
    flat = tuple(v for pair in reversed(pw) for v in pair)
    return torch.nn.functional.pad(x, flat)

kernel_name = 'standalone__swiglu_ffn__sampling'

def setup_inputs():

    _w = (lambda a: (lambda t: t.to(torch.bfloat16) if t.is_floating_point() else t)(torch.as_tensor(a)))
    B, S, D, F = 32, 32, 1024, 3584
    return {
        "x": _w((lambda *s: torch.randn(*s, dtype=torch.bfloat16) * 0.05)(B, S, D)),
        "w_gate": _w((lambda *s: torch.randn(*s, dtype=torch.bfloat16) * 0.05)(D, F)),
        "w_up": _w((lambda *s: torch.randn(*s, dtype=torch.bfloat16) * 0.05)(D, F)),
        "w_down": _w((lambda *s: torch.randn(*s, dtype=torch.bfloat16) * 0.05)(F, D)),
    }

def reference(x, w_gate, w_up, w_down):
    g = _silu(x @ w_gate)
    u = x @ w_up
    return (g * u) @ w_down
```

```asm
; @launch grid=(256,1,1) block=(256,1,1) lds=163840
.amdgcn_target "amdgcn-amd-amdhsa--gfx950"
.text
.globl standalone__swiglu_ffn__sampling_kernel
.p2align 12
.p2align 8
.type standalone__swiglu_ffn__sampling_kernel,@function
standalone__swiglu_ffn__sampling_kernel:
    s_cmp_ge_u32 s2, 256
    s_cbranch_scc1 L_END
    s_load_dwordx2 s[24:25], s[0:1], 8
    s_load_dwordx2 s[28:29], s[0:1], 16
    s_load_dwordx2 s[20:21], s[0:1], 0
    s_load_dwordx2 s[32:33], s[0:1], 24
    s_load_dwordx2 s[36:37], s[0:1], 32
    s_load_dwordx2 s[40:41], s[0:1], 40
    s_load_dwordx2 s[44:45], s[0:1], 48
    v_lshrrev_b32 v128, 6, v0
    v_and_b32 v254, 63, v0
    v_readfirstlane_b32 s48, v128
    s_and_b32 s61, s2, 7
    s_lshr_b32 s62, s2, 3
    s_and_b32 s49, s62, 3
    s_lshr_b32 s67, s62, 2
    s_lshl_b32 s63, s61, 2
    s_lshr_b32 s63, 0x65403210, s63
    s_and_b32 s63, s63, 15
    s_add_u32 s63, s63, s67
    s_sub_u32 s64, s63, 7
    s_cselect_b32 s63, s63, s64
    s_mul_i32 s50, s61, 7
    s_add_u32 s50, s50, s63
    s_lshr_b32 s65, s61, 1
    s_lshl_b32 s56, s48, 11
    s_lshr_b32 s62, s61, 1
    s_add_u32 s63, s49, s67
    s_and_b32 s63, s63, 3
    s_lshl_b32 s63, s63, 2
    s_lshr_b32 s64, 0x32103210, s63
    s_pack_ll_b32_b16 s74, s64, s64
    s_or_b32 s74, s74, 0x44440000
    s_mov_b32 s64, 0x32103210
    s_cmp_eq_u32 s62, 1
    s_cselect_b32 s64, 0x10210210, s64
    s_cmp_eq_u32 s62, 2
    s_cselect_b32 s64, 0x10101010, s64
    s_cmp_eq_u32 s62, 3
    s_cselect_b32 s64, 0x0, s64
    s_lshr_b32 s64, s64, s63
    s_or_b32 s75, s64, 0x88888888
    s_mul_i32 s64, s62, 0x11111111
    s_add_u32 s74, s74, s64
    s_add_u32 s75, s75, s64
    s_lshl_b32 s62, s62, 2
    s_mov_b32 s59, s62
    s_lshl_b64 s[74:75], s[74:75], s62
    s_cmp_eq_u32 s62, 12
    s_cselect_b32 s64, 0x10210210, 0
    s_cmp_eq_u32 s62, 8
    s_cselect_b32 s64, 0x10101010, s64
    s_lshr_b32 s64, s64, s63
    s_bfm_b32 s62, s62, 0
    s_and_b32 s64, s64, s62
    s_or_b32 s74, s74, s64
    s_lshr_b32 s64, 0xedcfedc, s63
    s_lshl_b32 s64, s64, 16
    s_and_b32 s75, s75, 0xffff
    s_or_b32 s75, s75, s64
    s_mul_i32 s63, s48, 114688
    s_lshl_b32 s64, s50, 7
    s_add_u32 s63, s63, s64
    v_lshrrev_b32 v128, 2, v254
    v_mul_u32_u24 v131, 7168, v128
    v_lshrrev_b32 v129, 4, v254
    v_and_b32 v129, 2, v129
    v_and_b32 v130, 3, v254
    v_xor_b32 v129, v129, v130
    v_lshl_add_u32 v131, v129, 4, v131
    v_add_u32 v226, s63, v131
    v_add_u32 v227, 64, v226
    v_lshrrev_b32 v128, 3, v254
    v_lshlrev_b32 v128, 11, v128
    v_and_b32 v129, 7, v254
    v_lshrrev_b32 v130, 4, v254
    v_xor_b32 v129, v129, v130
    v_lshl_add_u32 v224, v129, 4, v128
    v_xor_b32 v225, 64, v224
    v_add_u32 v225, 15360, v225
    s_lshl_b32 s63, s49, 19
    s_lshr_b32 s64, s48, 1
    s_lshl_b32 s64, s64, 18
    s_add_u32 s63, s63, s64
    s_and_b32 s64, s48, 1
    s_lshl_b32 s64, s64, 15
    s_add_u32 s63, s63, s64
    s_lshl_b32 s64, s65, 16
    s_and_b32 s61, s67, 4
    s_lshl_b32 s98, s61, 11
    s_or_b32 s98, s98, s56
    s_lshl_b32 s61, s61, 14
    s_add_u32 s64, s64, 0x10000
    s_xor_b32 s62, s61, 0
    s_add_u32 s62, s62, s64
    s_and_b32 s62, s62, 0x30000
    s_add_u32 s52, s62, s63
    s_xor_b32 s62, s61, 65536
    s_add_u32 s62, s62, s64
    s_and_b32 s62, s62, 0x30000
    s_add_u32 s53, s62, s63
    s_xor_b32 s62, s61, 131072
    s_add_u32 s62, s62, s64
    s_and_b32 s62, s62, 0x30000
    s_add_u32 s54, s62, s63
    s_xor_b32 s62, s61, 196608
    s_add_u32 s62, s62, s64
    s_and_b32 s62, s62, 0x30000
    s_add_u32 s55, s62, s63
    s_mov_b32 s26, 7340032
    s_mov_b32 s27, 0x20000
    s_mov_b32 s30, 7340032
    s_mov_b32 s31, 0x20000
    s_mov_b32 s22, 2097152
    s_mov_b32 s23, 0x20000
    s_mov_b32 s34, 7340032
    s_mov_b32 s35, 0x20000
    s_mov_b32 s38, 2097152
    s_mov_b32 s39, 0x20000
    s_mov_b32 s42, 256
    s_mov_b32 s43, 0x20000
    s_mov_b32 s46, 33554432
    s_mov_b32 s47, 0x20000
    s_bfe_u32 s6, s74, 0x40000
    s_mul_i32 s4, s6, 458752
    s_lshl_b32 s7, s6, 7
    s_waitcnt lgkmcnt(0)
    s_add_u32 s44, s44, 234881024
    s_addc_u32 s45, s45, 0
    s_cmp_ge_u32 s2, 224
    s_cbranch_scc1 L_PF
    s_add_u32 m0, s56, 98304
    s_nop 0
    buffer_load_dwordx4 v226, s[24:27], s4 offen lds
    s_add_u32 m0, s56, 99328
    s_nop 0
    buffer_load_dwordx4 v227, s[24:27], s4 offen lds
    s_add_u32 m0, s56, 106496
    s_nop 0
    buffer_load_dwordx4 v226, s[28:31], s4 offen lds
    s_add_u32 m0, s56, 107520
    s_nop 0
    buffer_load_dwordx4 v227, s[28:31], s4 offen lds
    s_xor_b32 m0, s98, 0
    s_add_u32 s8, s52, s7
    buffer_load_dwordx4 v224, s[20:23], s8 offen lds
    buffer_load_dwordx4 v225, s[20:23], s8 offen offset:1024 lds
    s_xor_b32 m0, s98, 16384
    s_add_u32 s9, s54, s7
    buffer_load_dwordx4 v224, s[20:23], s9 offen lds
    buffer_load_dwordx4 v225, s[20:23], s9 offen offset:1024 lds
    s_xor_b32 m0, s98, 8192
    s_add_u32 s8, s53, s7
    buffer_load_dwordx4 v224, s[20:23], s8 offen lds
    buffer_load_dwordx4 v225, s[20:23], s8 offen offset:1024 lds
    s_xor_b32 m0, s98, 24576
    s_add_u32 s9, s55, s7
    buffer_load_dwordx4 v224, s[20:23], s9 offen lds
    buffer_load_dwordx4 v225, s[20:23], s9 offen offset:1024 lds
    s_branch L_COMMON
L_PF:
    s_lshl2_add_u32 s61, s49, s48
    v_mul_u32_u24 v132, 7168, v254
    v_lshlrev_b32 v133, 11, v254
    s_lshl_b32 s60, s61, 17
    s_and_b32 s63, s2, 7
    s_mul_i32 s63, s63, 7
    s_sub_u32 s64, s50, s63
    s_add_u32 s64, s64, 3
    s_sub_u32 s11, s64, 7
    s_cselect_b32 s64, s64, s11
    s_add_u32 s64, s64, s63
    s_lshl_b32 s11, s64, 7
    s_and_b32 s64, s61, 1
    s_mul_i32 s64, s64, 229376
    s_add_u32 s11, s11, s64
    s_lshr_b32 s10, s59, 2
    s_add_u32 s8, s10, s49
    s_bitcmp1_b32 s48, 1
    s_cselect_b32 s24, s28, s24
    s_cselect_b32 s25, s29, s25
    s_add_u32 s64, s8, 0
    s_min_u32 s64, s64, 15
    s_mul_i32 s64, s64, 458752
    s_add_u32 s64, s64, s11
    s_mov_b32 exec_hi, 0
    buffer_load_dword v137, v132, s[24:27], s64 offen
    s_mov_b32 exec_hi, -1
    s_mul_i32 s4, s65, 1835008
    s_lshl_b32 s64, s61, 13
    s_add_u32 s4, s4, s64
    s_and_b32 s64, s2, 1
    s_mul_i32 s64, s64, 393216
    v_lshlrev_b32 v134, 7, v254
    v_and_b32 v135, 7, v254
    v_xor_b32 v135, 4, v135
    v_lshl_add_u32 v134, v135, 17, v134
    v_add_u32 v134, s64, v134
    v_subrev_u32 v135, 917504, v134
    v_min_u32 v134, v134, v135
    s_add_u32 s64, s4, 0
    s_mov_b32 exec_lo, 0xf7f7f7f7
    s_mov_b32 exec_hi, 0xf7f7f7f7
    buffer_load_dword v138, v134, s[32:35], s64 offen
    s_mov_b64 exec, -1
    s_mov_b64 exec, 0
    s_cmp_eq_u32 s61, 0
    s_cbranch_scc1 L_D1_4
    s_cmp_eq_u32 s61, 1
    s_cbranch_scc1 L_D1_8
    s_cmp_eq_u32 s61, 2
    s_cbranch_scc1 L_D1_12
    s_cmp_eq_u32 s61, 3
    s_cbranch_scc1 L_D1_16
    s_cmp_eq_u32 s61, 4
    s_cbranch_scc1 L_D1_20
    s_cmp_eq_u32 s61, 5
    s_cbranch_scc1 L_D1_24
    s_cmp_eq_u32 s61, 6
    s_cbranch_scc1 L_D1_28
    s_cmp_eq_u32 s61, 7
    s_cbranch_scc1 L_D1_2
L_DW1:
    s_mov_b64 exec, -1
    s_branch L_PFB
L_COMMON:
    v_lshlrev_b32 v252, 4, v254
    s_and_b32 s60, s48, 1
    s_lshl_b32 s63, s60, 10
    v_bfe_u32 v129, v254, 4, 1
    v_and_b32 v130, 3, v254
    v_lshrrev_b32 v128, 5, v254
    v_lshlrev_b32 v128, 11, v128
    v_mul_u32_u24 v131, 544, v129
    v_add3_u32 v128, v128, v131, s63
    v_bfe_u32 v131, v254, 2, 2
    v_lshl_add_u32 v128, v131, 6, v128
    v_lshl_add_u32 v228, v130, 3, v128
    v_xor_b32 v229, 32, v228
    v_add_u32 v230, 65536, v228
    v_add_u32 v231, 65536, v229
    v_add_u32 v232, 131072, v228
    v_add_u32 v233, 131072, v229
    v_lshrrev_b32 v131, 2, v254
    v_lshlrev_b32 v128, 6, v131
    v_lshl_add_u32 v128, v130, 3, v128
    v_lshl_add_u32 v128, v129, 5, v128
    v_add_u32 v236, s56, v128
    v_xor_b32 v237, 32, v236
    v_add_u32 v238, 65536, v236
    v_add_u32 v239, 65536, v237
    v_add_u32 v240, 131072, v236
    v_add_u32 v241, 131072, v237
    v_lshlrev_b32 v129, 1, v129
    v_xor_b32 v129, v129, v130
    v_lshlrev_b32 v129, 4, v129
    v_lshl_add_u32 v234, v131, 11, v129
    v_add_u32 v235, 31744, v234
    s_and_b32 s63, s56, 4096
    v_and_b32 v128, 15, v254
    v_lshlrev_b32 v129, 7, v128
    v_add_u32 v129, s63, v129
    v_lshrrev_b32 v128, 1, v128
    v_lshrrev_b32 v130, 4, v254
    v_xor_b32 v128, v128, v130
    v_lshl_add_u32 v242, v128, 4, v129
    v_xor_b32 v243, 64, v242
    v_add_u32 v244, 65536, v242
    v_add_u32 v245, 65536, v243
    v_add_u32 v246, 131072, v242
    v_add_u32 v247, 131072, v243
    s_and_b32 s61, s2, 1
    s_lshl2_add_u32 s66, s61, s49
    s_mov_b32 s3, s67
    s_lshl_b32 s57, s48, 12
    s_mul_i32 s61, s61, 3
    s_add_u32 s61, s61, s3
    s_sub_u32 s62, s61, 7
    s_cselect_b32 s61, s61, s62
    s_lshl_b32 s61, s61, 2
    s_mov_b32 s94, 0x06543210
    s_mov_b32 s95, 0x654321
    s_lshr_b64 s[94:95], s[94:95], s61
    s_mov_b32 s58, s94
    s_lshl2_add_u32 s61, s60, s61
    s_lshr_b32 s61, 0x03625140, s61
    s_and_b32 s61, s61, 15
    s_lshl_b32 s61, s61, 2
    s_mov_b32 s94, 0x05316420
    s_mov_b32 s95, 0x531642
    s_lshr_b64 s[94:95], s[94:95], s61
    s_lshl_b32 s61, s60, 15
    s_or_b32 s61, s61, 0x8880000
    s_or_b32 s93, s94, s61
    s_xor_b32 s63, s3, 4
    s_lshl1_add_u32 s63, s63, s60
    s_lshr_b32 s64, s48, 1
    s_lshl4_add_u32 s64, s64, s63
    s_lshl_b32 s64, s64, 6
    s_mul_i32 s69, s65, 1835008
    s_add_u32 s69, s69, s64
    s_lshl_b32 s61, s66, 18
    s_lshl_b32 s62, s65, 16
    s_add_u32 s61, s61, s62
    s_add_u32 s92, s61, s64
    s_lshr_b32 s63, s48, 1
    s_lshl1_add_u32 s61, s49, s63
    s_lshl_b32 s70, s61, 9
    s_add_u32 s70, s70, s50
    s_and_b32 s62, s2, 7
    s_mul_i32 s62, s62, 9
    s_add_u32 s70, s70, s62
    s_lshl1_add_u32 s70, s70, s60
    s_lshl_b32 s70, s70, 10
    s_and_b32 s62, s2, 7
    s_lshl3_add_u32 s61, s61, s62
    s_lshl_b32 s61, s61, 9
    s_mul_i32 s62, s60, 7
    s_add_u32 s62, s62, s67
    s_lshl3_add_u32 s71, s62, s61
    s_add_u32 s71, s71, 8388608
    s_lshl1_add_u32 s62, s65, s63
    s_lshl3_add_u32 s61, s66, s62
    s_lshl_b32 s61, s61, 9
    s_add_u32 s72, s61, 8388608
    s_lshl_b32 s61, s66, 20
    s_lshl_b32 s62, s62, 15
    s_add_u32 s73, s61, s62
    s_lshl3_add_u32 s61, s66, s3
    s_mul_i32 s61, s61, 196608
    s_add_u32 s61, s61, s57
    s_add_u32 s61, s61, 16777216
    s_mul_i32 s62, s65, 49152
    s_add_u32 s91, s61, s62
    s_add_u32 s62, s65, 1
    s_and_b32 s62, s62, 3
    s_mul_i32 s62, s62, 49152
    s_add_u32 s62, s62, s61
    s_add_u32 s88, s62, 0
    s_add_u32 s62, s65, 2
    s_and_b32 s62, s62, 3
    s_mul_i32 s62, s62, 49152
    s_add_u32 s62, s62, s61
    s_add_u32 s89, s62, 16384
    s_add_u32 s62, s65, 3
    s_and_b32 s62, s62, 3
    s_mul_i32 s62, s62, 49152
    s_add_u32 s62, s62, s61
    s_add_u32 s90, s62, 32768
    s_mov_b32 s76, 0xbfb8aa3b
    s_mov_b32 s77, 0xbfb8aa3b
    s_mov_b32 s78, 1.0
    s_mov_b32 s79, 1.0
    s_mov_b32 s81, 0x7060501
    s_mov_b32 s82, 0x7060502
    s_mov_b32 s83, 0x7060503
    s_mov_b32 s80, 0x0303
    s_mov_b32 s84, 0x04000c0c
    s_mov_b32 s85, 0x0706000c
    v_min_u32 v253, 13, v254
    v_lshlrev_b32 v253, 3, v253
    s_mov_b32 s86, s49
    s_mul_i32 s61, s60, 0x8888888
    s_or_b32 s49, s58, s61
    s_mov_b32 s50, s93
    s_mov_b64 exec, 0
    s_cmp_eq_u32 s48, 0
    s_cbranch_scc1 L_ST0
    s_cmp_eq_u32 s48, 1
    s_cbranch_scc1 L_ST1
    s_cmp_eq_u32 s48, 2
    s_cbranch_scc1 L_ST2
    s_cmp_eq_u32 s48, 3
    s_cbranch_scc1 L_ST3
L_WALKED:
    s_mov_b64 exec, -1
    s_cmp_ge_u32 s2, 224
    s_cbranch_scc1 L_SPARE
    s_add_u32 m0, s56, 114688
    s_bfe_u32 s6, s74, 0x40004
    s_mul_i32 s5, s6, 458752
L_D1_2:
    s_cbranch_execz L_DW1
    buffer_load_dwordx4 v226, s[24:27], s5 offen lds
    s_add_u32 m0, s56, 115712
    s_nop 0
    buffer_load_dwordx4 v227, s[24:27], s5 offen lds
    s_add_u32 m0, s56, 122880
    s_nop 0
    buffer_load_dwordx4 v226, s[28:31], s5 offen lds
    s_add_u32 m0, s56, 123904
    s_nop 0
    buffer_load_dwordx4 v227, s[28:31], s5 offen lds
    s_xor_b32 m0, s98, 32768
    s_bfe_u32 s7, s74, 0x40004
    s_lshl_b32 s7, s7, 7
    s_add_u32 s8, s52, s7
    buffer_load_dwordx4 v224, s[20:23], s8 offen lds
    buffer_load_dwordx4 v225, s[20:23], s8 offen offset:1024 lds
    s_xor_b32 m0, s98, 49152
    s_add_u32 s9, s54, s7
    buffer_load_dwordx4 v224, s[20:23], s9 offen lds
    buffer_load_dwordx4 v225, s[20:23], s9 offen offset:1024 lds
    s_xor_b32 m0, s98, 40960
    s_add_u32 s8, s53, s7
    buffer_load_dwordx4 v224, s[20:23], s8 offen lds
    s_waitcnt vmcnt(11)
    s_barrier
    ds_read_b128 v[128:131], v242 offset:0
    ds_read_b64_tr_b16 a[0:1], v230 offset:32768
    ds_read_b64_tr_b16 a[2:3], v230 offset:33024
    ds_read_b64_tr_b16 a[4:5], v231 offset:32768
    ds_read_b64_tr_b16 a[6:7], v231 offset:33024
    ds_read_b64_tr_b16 a[8:9], v230 offset:40960
    ds_read_b64_tr_b16 a[10:11], v230 offset:41216
    ds_read_b64_tr_b16 a[12:13], v231 offset:40960
    ds_read_b64_tr_b16 a[14:15], v231 offset:41216
    ds_read_b128 v[132:135], v242 offset:2048
    ds_read_b128 v[136:139], v243 offset:0
    ds_read_b128 v[140:143], v243 offset:2048
    ds_read_b128 v[144:147], v242 offset:8192
    ds_read_b128 v[148:151], v242 offset:10240
    ds_read_b128 v[152:155], v243 offset:8192
    s_waitcnt lgkmcnt(6)
    v_mfma_f32_16x16x32_bf16 v[0:3], a[0:3], v[128:131], 0
    ds_read_b128 v[156:159], v243 offset:10240
    s_add_u32 s9, s55, s7
    v_mfma_f32_16x16x32_bf16 v[4:7], a[4:7], v[128:131], 0
    buffer_load_dwordx4 v225, s[20:23], s8 offen offset:1024 lds
    v_mfma_f32_16x16x32_bf16 v[8:11], a[8:11], v[128:131], 0
    ds_read_b64_tr_b16 a[16:17], v230 offset:36864
    s_xor_b32 m0, s98, 57344
    v_mfma_f32_16x16x32_bf16 v[12:15], a[12:15], v[128:131], 0
    ds_read_b64_tr_b16 a[18:19], v230 offset:37120
    s_waitcnt lgkmcnt(8)
    v_mfma_f32_16x16x32_bf16 v[16:19], a[0:3], v[132:135], 0
    buffer_load_dwordx4 v224, s[20:23], s9 offen lds
    v_mfma_f32_16x16x32_bf16 v[20:23], a[4:7], v[132:135], 0
    ds_read_b64_tr_b16 a[20:21], v231 offset:36864
    s_bfe_u32 s6, s74, 0x40008
    v_mfma_f32_16x16x32_bf16 v[24:27], a[8:11], v[132:135], 0
    ds_read_b64_tr_b16 a[22:23], v231 offset:37120
    s_mul_i32 s4, s6, 458752
    v_mfma_f32_16x16x32_bf16 v[28:31], a[12:15], v[132:135], 0
    ds_read_b64_tr_b16 a[24:25], v230 offset:45056
    ds_read_b64_tr_b16 a[26:27], v230 offset:45312
    ds_read_b64_tr_b16 a[28:29], v231 offset:45056
    ds_read_b64_tr_b16 a[30:31], v231 offset:45312
    s_waitcnt lgkmcnt(0)
    v_mfma_f32_16x16x32_bf16 v[0:3], a[16:19], v[136:139], v[0:3]
    buffer_load_dwordx4 v225, s[20:23], s9 offen offset:1024 lds
    v_mfma_f32_16x16x32_bf16 v[4:7], a[20:23], v[136:139], v[4:7]
    s_add_u32 m0, s56, 131072
    v_mfma_f32_16x16x32_bf16 v[8:11], a[24:27], v[136:139], v[8:11]
    v_mfma_f32_16x16x32_bf16 v[12:15], a[28:31], v[136:139], v[12:15]
    v_mfma_f32_16x16x32_bf16 v[16:19], a[16:19], v[140:143], v[16:19]
    v_mfma_f32_16x16x32_bf16 v[20:23], a[20:23], v[140:143], v[20:23]
    buffer_load_dwordx4 v226, s[24:27], s4 offen lds
    v_mfma_f32_16x16x32_bf16 v[24:27], a[24:27], v[140:143], v[24:27]
    s_add_u32 m0, s56, 132096
    v_mfma_f32_16x16x32_bf16 v[28:31], a[28:31], v[140:143], v[28:31]
    v_mfma_f32_16x16x32_bf16 v[32:35], a[0:3], v[144:147], 0
    buffer_load_dwordx4 v227, s[24:27], s4 offen lds
    s_add_u32 m0, s56, 139264
    s_nop 0
    buffer_load_dwordx4 v226, s[28:31], s4 offen lds
    s_waitcnt vmcnt(11)
    s_barrier
    ds_read_b128 v[160:163], v242 offset:16384
    s_add_u32 m0, s56, 140288
    v_mfma_f32_16x16x32_bf16 v[36:39], a[4:7], v[144:147], 0
    ds_read_b128 v[164:167], v242 offset:18432
    s_bfe_u32 s7, s74, 0x40008
    v_mfma_f32_16x16x32_bf16 v[40:43], a[8:11], v[144:147], 0
    ds_read_b128 v[168:171], v243 offset:16384
    s_lshl_b32 s7, s7, 7
    v_mfma_f32_16x16x32_bf16 v[44:47], a[12:15], v[144:147], 0
    ds_read_b128 v[172:175], v243 offset:18432
    s_add_u32 s8, s52, s7
    v_mfma_f32_16x16x32_bf16 v[48:51], a[0:3], v[148:151], 0
    ds_read_b128 v[128:131], v242 offset:24576
    v_mfma_f32_16x16x32_bf16 v[52:55], a[4:7], v[148:151], 0
    buffer_load_dwordx4 v227, s[28:31], s4 offen lds
    v_mfma_f32_16x16x32_bf16 v[56:59], a[8:11], v[148:151], 0
    ds_read_b64_tr_b16 a[32:33], v230 offset:49152
    s_xor_b32 m0, s98, 65536
    v_mfma_f32_16x16x32_bf16 v[60:63], a[12:15], v[148:151], 0
    ds_read_b64_tr_b16 a[34:35], v230 offset:49408
    v_mfma_f32_16x16x32_bf16 v[32:35], a[16:19], v[152:155], v[32:35]
    ds_read_b128 v[132:135], v242 offset:26624
    v_mfma_f32_16x16x32_bf16 v[36:39], a[20:23], v[152:155], v[36:39]
    buffer_load_dwordx4 v224, s[20:23], s8 offen lds
    v_mfma_f32_16x16x32_bf16 v[40:43], a[24:27], v[152:155], v[40:43]
    ds_read_b64_tr_b16 a[36:37], v231 offset:49152
    s_add_u32 s9, s54, s7
    v_mfma_f32_16x16x32_bf16 v[44:47], a[28:31], v[152:155], v[44:47]
    ds_read_b64_tr_b16 a[38:39], v231 offset:49408
    v_mfma_f32_16x16x32_bf16 v[48:51], a[16:19], v[156:159], v[48:51]
    ds_read_b128 v[136:139], v243 offset:24576
    v_mfma_f32_16x16x32_bf16 v[52:55], a[20:23], v[156:159], v[52:55]
    buffer_load_dwordx4 v225, s[20:23], s8 offen offset:1024 lds
    v_mfma_f32_16x16x32_bf16 v[56:59], a[24:27], v[156:159], v[56:59]
    ds_read_b64_tr_b16 a[48:49], v230 offset:53248
    s_xor_b32 m0, s98, 81920
    v_mfma_f32_16x16x32_bf16 v[60:63], a[28:31], v[156:159], v[60:63]
    ds_read_b64_tr_b16 a[50:51], v230 offset:53504
    s_waitcnt lgkmcnt(12)
    v_mfma_f32_16x16x32_bf16 v[64:67], a[0:3], v[160:163], 0
    ds_read_b128 v[140:143], v243 offset:26624
    v_mfma_f32_16x16x32_bf16 v[68:71], a[4:7], v[160:163], 0
    buffer_load_dwordx4 v224, s[20:23], s9 offen lds
    v_mfma_f32_16x16x32_bf16 v[72:75], a[8:11], v[160:163], 0
    ds_read_b64_tr_b16 a[52:53], v231 offset:53248
    s_add_u32 s8, s53, s7
    v_mfma_f32_16x16x32_bf16 v[76:79], a[12:15], v[160:163], 0
    ds_read_b64_tr_b16 a[54:55], v231 offset:53504
    s_waitcnt lgkmcnt(14)
    v_mfma_f32_16x16x32_bf16 v[80:83], a[0:3], v[164:167], 0
    buffer_load_dwordx4 v225, s[20:23], s9 offen offset:1024 lds
    v_mfma_f32_16x16x32_bf16 v[84:87], a[4:7], v[164:167], 0
    ds_read_b64_tr_b16 a[40:41], v230 offset:57344
    s_xor_b32 m0, s98, 73728
    v_mfma_f32_16x16x32_bf16 v[88:91], a[8:11], v[164:167], 0
    ds_read_b64_tr_b16 a[42:43], v230 offset:57600
    v_mfma_f32_16x16x32_bf16 v[92:95], a[12:15], v[164:167], 0
    ds_read_b64_tr_b16 a[44:45], v231 offset:57344
    s_waitcnt lgkmcnt(15)
    v_mfma_f32_16x16x32_bf16 v[64:67], a[16:19], v[168:171], v[64:67]
    buffer_load_dwordx4 v224, s[20:23], s8 offen lds
    v_mfma_f32_16x16x32_bf16 v[68:71], a[20:23], v[168:171], v[68:71]
    ds_read_b64_tr_b16 a[46:47], v231 offset:57600
    s_add_u32 s9, s55, s7
    v_mfma_f32_16x16x32_bf16 v[72:75], a[24:27], v[168:171], v[72:75]
    ds_read_b64_tr_b16 a[56:57], v230 offset:61440
    v_mfma_f32_16x16x32_bf16 v[76:79], a[28:31], v[168:171], v[76:79]
    buffer_load_dwordx4 v225, s[20:23], s8 offen offset:1024 lds
    v_mfma_f32_16x16x32_bf16 v[80:83], a[16:19], v[172:175], v[80:83]
    ds_read_b64_tr_b16 a[58:59], v230 offset:61696
    s_xor_b32 m0, s98, 90112
    v_mfma_f32_16x16x32_bf16 v[84:87], a[20:23], v[172:175], v[84:87]
    ds_read_b64_tr_b16 a[60:61], v231 offset:61440
    v_mfma_f32_16x16x32_bf16 v[88:91], a[24:27], v[172:175], v[88:91]
    ds_read_b64_tr_b16 a[62:63], v231 offset:61696
    v_mfma_f32_16x16x32_bf16 v[92:95], a[28:31], v[172:175], v[92:95]
    s_waitcnt lgkmcnt(15)
    v_mfma_f32_16x16x32_bf16 v[96:99], a[0:3], v[128:131], 0
    s_waitcnt vmcnt(12) lgkmcnt(8)
    s_barrier
    ds_read_b128 v[144:147], v242 offset:32768
    v_mfma_f32_16x16x32_bf16 v[100:103], a[4:7], v[128:131], 0
    ds_read_b128 v[148:151], v242 offset:34816
    v_mfma_f32_16x16x32_bf16 v[104:107], a[8:11], v[128:131], 0
    ds_read_b128 v[152:155], v243 offset:32768
    v_mfma_f32_16x16x32_bf16 v[108:111], a[12:15], v[128:131], 0
    ds_read_b128 v[156:159], v243 offset:34816
    v_mfma_f32_16x16x32_bf16 v[112:115], a[0:3], v[132:135], 0
    ds_read_b128 v[160:163], v242 offset:40960
    v_mfma_f32_16x16x32_bf16 v[116:119], a[4:7], v[132:135], 0
    buffer_load_dwordx4 v224, s[20:23], s9 offen lds
    v_mfma_f32_16x16x32_bf16 v[120:123], a[8:11], v[132:135], 0
    s_bfe_u32 s6, s74, 0x4000c
    s_mul_i32 s5, s6, 458752
    v_mfma_f32_16x16x32_bf16 v[124:127], a[12:15], v[132:135], 0
    v_mfma_f32_16x16x32_bf16 v[96:99], a[16:19], v[136:139], v[96:99]
    ds_read_b128 v[164:167], v242 offset:43008
    v_mfma_f32_16x16x32_bf16 v[100:103], a[20:23], v[136:139], v[100:103]
    buffer_load_dwordx4 v225, s[20:23], s9 offen offset:1024 lds
    v_mfma_f32_16x16x32_bf16 v[104:107], a[24:27], v[136:139], v[104:107]
    s_add_u32 m0, s56, 114688
    v_mfma_f32_16x16x32_bf16 v[108:111], a[28:31], v[136:139], v[108:111]
    v_mfma_f32_16x16x32_bf16 v[112:115], a[16:19], v[140:143], v[112:115]
    ds_read_b128 v[168:171], v243 offset:40960
    v_mfma_f32_16x16x32_bf16 v[116:119], a[20:23], v[140:143], v[116:119]
    buffer_load_dwordx4 v226, s[24:27], s5 offen lds
    v_mfma_f32_16x16x32_bf16 v[120:123], a[24:27], v[140:143], v[120:123]
    s_add_u32 m0, s56, 115712
    v_mfma_f32_16x16x32_bf16 v[124:127], a[28:31], v[140:143], v[124:127]
    s_waitcnt lgkmcnt(6)
    v_mfma_f32_16x16x32_bf16 v[0:3], a[32:35], v[144:147], v[0:3]
    ds_read_b128 v[172:175], v243 offset:43008
    v_mfma_f32_16x16x32_bf16 v[4:7], a[36:39], v[144:147], v[4:7]
    buffer_load_dwordx4 v227, s[24:27], s5 offen lds
    v_mfma_f32_16x16x32_bf16 v[8:11], a[40:43], v[144:147], v[8:11]
    s_add_u32 m0, s56, 147456
    v_mfma_f32_16x16x32_bf16 v[12:15], a[44:47], v[144:147], v[12:15]
    s_waitcnt lgkmcnt(6)
    v_mfma_f32_16x16x32_bf16 v[16:19], a[32:35], v[148:151], v[16:19]
    buffer_load_dwordx4 v226, s[28:31], s5 offen lds
    v_mfma_f32_16x16x32_bf16 v[20:23], a[36:39], v[148:151], v[20:23]
    s_add_u32 m0, s56, 148480
    s_bfe_u32 s7, s74, 0x4000c
    s_lshl_b32 s7, s7, 7
    v_mfma_f32_16x16x32_bf16 v[24:27], a[40:43], v[148:151], v[24:27]
    s_add_u32 s8, s52, s7
    v_mfma_f32_16x16x32_bf16 v[28:31], a[44:47], v[148:151], v[28:31]
    s_waitcnt lgkmcnt(5)
    v_mfma_f32_16x16x32_bf16 v[0:3], a[48:51], v[152:155], v[0:3]
    buffer_load_dwordx4 v227, s[28:31], s5 offen lds
    v_mfma_f32_16x16x32_bf16 v[4:7], a[52:55], v[152:155], v[4:7]
    s_xor_b32 m0, s98, 0
    v_mfma_f32_16x16x32_bf16 v[8:11], a[56:59], v[152:155], v[8:11]
    v_mfma_f32_16x16x32_bf16 v[12:15], a[60:63], v[152:155], v[12:15]
    s_waitcnt lgkmcnt(4)
    v_mfma_f32_16x16x32_bf16 v[16:19], a[48:51], v[156:159], v[16:19]
    buffer_load_dwordx4 v224, s[20:23], s8 offen lds
    v_mfma_f32_16x16x32_bf16 v[20:23], a[52:55], v[156:159], v[20:23]
    s_add_u32 s9, s54, s7
    v_mfma_f32_16x16x32_bf16 v[24:27], a[56:59], v[156:159], v[24:27]
    v_mfma_f32_16x16x32_bf16 v[28:31], a[60:63], v[156:159], v[28:31]
    s_waitcnt lgkmcnt(3)
    v_mfma_f32_16x16x32_bf16 v[32:35], a[32:35], v[160:163], v[32:35]
    s_waitcnt vmcnt(13) lgkmcnt(0)
    s_barrier
    ds_read_b128 v[128:131], v242 offset:49152
    v_mfma_f32_16x16x32_bf16 v[36:39], a[36:39], v[160:163], v[36:39]
    ds_read_b128 v[132:135], v242 offset:51200
    v_mfma_f32_16x16x32_bf16 v[40:43], a[40:43], v[160:163], v[40:43]
    ds_read_b128 v[136:139], v243 offset:49152
    v_mfma_f32_16x16x32_bf16 v[44:47], a[44:47], v[160:163], v[44:47]
    ds_read_b128 v[140:143], v243 offset:51200
    v_mfma_f32_16x16x32_bf16 v[48:51], a[32:35], v[164:167], v[48:51]
    ds_read_b128 v[144:147], v242 offset:57344
    v_mfma_f32_16x16x32_bf16 v[52:55], a[36:39], v[164:167], v[52:55]
    buffer_load_dwordx4 v225, s[20:23], s8 offen offset:1024 lds
    v_mfma_f32_16x16x32_bf16 v[56:59], a[40:43], v[164:167], v[56:59]
    ds_read_b64_tr_b16 a[64:65], v232 offset:0
    s_xor_b32 m0, s98, 16384
    v_mfma_f32_16x16x32_bf16 v[60:63], a[44:47], v[164:167], v[60:63]
    ds_read_b64_tr_b16 a[66:67], v232 offset:256
    v_mfma_f32_16x16x32_bf16 v[32:35], a[48:51], v[168:171], v[32:35]
    ds_read_b128 v[148:151], v242 offset:59392
    v_mfma_f32_16x16x32_bf16 v[36:39], a[52:55], v[168:171], v[36:39]
    buffer_load_dwordx4 v224, s[20:23], s9 offen lds
    v_mfma_f32_16x16x32_bf16 v[40:43], a[56:59], v[168:171], v[40:43]
    ds_read_b64_tr_b16 a[68:69], v233 offset:0
    s_add_u32 s8, s53, s7
    v_mfma_f32_16x16x32_bf16 v[44:47], a[60:63], v[168:171], v[44:47]
    ds_read_b64_tr_b16 a[70:71], v233 offset:256
    v_mfma_f32_16x16x32_bf16 v[48:51], a[48:51], v[172:175], v[48:51]
    ds_read_b128 v[152:155], v243 offset:57344
    v_mfma_f32_16x16x32_bf16 v[52:55], a[52:55], v[172:175], v[52:55]
    buffer_load_dwordx4 v225, s[20:23], s9 offen offset:1024 lds
    v_mfma_f32_16x16x32_bf16 v[56:59], a[56:59], v[172:175], v[56:59]
    ds_read_b64_tr_b16 a[80:81], v232 offset:4096
    s_xor_b32 m0, s98, 8192
    v_mfma_f32_16x16x32_bf16 v[60:63], a[60:63], v[172:175], v[60:63]
    ds_read_b64_tr_b16 a[82:83], v232 offset:4352
    s_waitcnt lgkmcnt(12)
    v_mfma_f32_16x16x32_bf16 v[64:67], a[32:35], v[128:131], v[64:67]
    ds_read_b128 v[156:159], v243 offset:59392
    v_mfma_f32_16x16x32_bf16 v[68:71], a[36:39], v[128:131], v[68:71]
    buffer_load_dwordx4 v224, s[20:23], s8 offen lds
    v_mfma_f32_16x16x32_bf16 v[72:75], a[40:43], v[128:131], v[72:75]
    ds_read_b64_tr_b16 a[84:85], v233 offset:4096
    s_add_u32 s9, s55, s7
    v_mfma_f32_16x16x32_bf16 v[76:79], a[44:47], v[128:131], v[76:79]
    ds_read_b64_tr_b16 a[86:87], v233 offset:4352
    s_waitcnt lgkmcnt(14)
    v_mfma_f32_16x16x32_bf16 v[80:83], a[32:35], v[132:135], v[80:83]
    buffer_load_dwordx4 v225, s[20:23], s8 offen offset:1024 lds
L_ST0:
    s_cbranch_execz L_ST4
L_D1_4:
    s_cbranch_execz L_DW1
    v_mfma_f32_16x16x32_bf16 v[84:87], a[36:39], v[132:135], v[84:87]
    ds_read_b64_tr_b16 a[72:73], v232 offset:8192
    s_xor_b32 m0, s98, 24576
    v_mfma_f32_16x16x32_bf16 v[88:91], a[40:43], v[132:135], v[88:91]
    ds_read_b64_tr_b16 a[74:75], v232 offset:8448
    v_mfma_f32_16x16x32_bf16 v[92:95], a[44:47], v[132:135], v[92:95]
    ds_read_b64_tr_b16 a[76:77], v233 offset:8192
    s_waitcnt lgkmcnt(15)
    v_mfma_f32_16x16x32_bf16 v[64:67], a[48:51], v[136:139], v[64:67]
    buffer_load_dwordx4 v224, s[20:23], s9 offen lds
    v_mfma_f32_16x16x32_bf16 v[68:71], a[52:55], v[136:139], v[68:71]
    ds_read_b64_tr_b16 a[78:79], v233 offset:8448
    s_bfe_u32 s6, s74, 0x40010
    v_mfma_f32_16x16x32_bf16 v[72:75], a[56:59], v[136:139], v[72:75]
    ds_read_b64_tr_b16 a[88:89], v232 offset:12288
    s_mul_i32 s4, s6, 458752
    v_mfma_f32_16x16x32_bf16 v[76:79], a[60:63], v[136:139], v[76:79]
    buffer_load_dwordx4 v225, s[20:23], s9 offen offset:1024 lds
    v_mfma_f32_16x16x32_bf16 v[80:83], a[48:51], v[140:143], v[80:83]
    ds_read_b64_tr_b16 a[90:91], v232 offset:12544
    s_add_u32 m0, s56, 155648
    v_mfma_f32_16x16x32_bf16 v[84:87], a[52:55], v[140:143], v[84:87]
    ds_read_b64_tr_b16 a[92:93], v233 offset:12288
    v_mfma_f32_16x16x32_bf16 v[88:91], a[56:59], v[140:143], v[88:91]
    buffer_load_dwordx4 v226, s[24:27], s4 offen lds
    v_mfma_f32_16x16x32_bf16 v[92:95], a[60:63], v[140:143], v[92:95]
    s_add_u32 m0, s56, 156672
    s_waitcnt lgkmcnt(15)
    v_mfma_f32_16x16x32_bf16 v[96:99], a[32:35], v[144:147], v[96:99]
    ds_read_b64_tr_b16 a[94:95], v233 offset:12544
    buffer_load_dwordx4 v227, s[24:27], s4 offen lds
    s_add_u32 m0, s56, 122880
    s_nop 0
    buffer_load_dwordx4 v226, s[28:31], s4 offen lds
    s_waitcnt vmcnt(11) lgkmcnt(8)
    s_barrier
    ds_read_b128 v[160:163], v244 offset:0
    s_add_u32 m0, s56, 123904
    v_mfma_f32_16x16x32_bf16 v[100:103], a[36:39], v[144:147], v[100:103]
    ds_read_b128 v[164:167], v244 offset:2048
    s_bfe_u32 s7, s74, 0x40010
    v_mfma_f32_16x16x32_bf16 v[104:107], a[40:43], v[144:147], v[104:107]
    ds_read_b128 v[168:171], v245 offset:0
    s_lshl_b32 s7, s7, 7
    v_mfma_f32_16x16x32_bf16 v[108:111], a[44:47], v[144:147], v[108:111]
    ds_read_b128 v[172:175], v245 offset:2048
    s_add_u32 s8, s52, s7
    v_mfma_f32_16x16x32_bf16 v[112:115], a[32:35], v[148:151], v[112:115]
    ds_read_b128 v[128:131], v244 offset:8192
    v_mfma_f32_16x16x32_bf16 v[116:119], a[36:39], v[148:151], v[116:119]
    buffer_load_dwordx4 v227, s[28:31], s4 offen lds
    v_mfma_f32_16x16x32_bf16 v[120:123], a[40:43], v[148:151], v[120:123]
    ds_read_b64_tr_b16 a[96:97], v230 offset:49152
    s_xor_b32 m0, s98, 32768
    v_mfma_f32_16x16x32_bf16 v[124:127], a[44:47], v[148:151], v[124:127]
    ds_read_b64_tr_b16 a[98:99], v230 offset:49408
    v_mfma_f32_16x16x32_bf16 v[96:99], a[48:51], v[152:155], v[96:99]
    ds_read_b128 v[132:135], v244 offset:10240
    v_mfma_f32_16x16x32_bf16 v[100:103], a[52:55], v[152:155], v[100:103]
    buffer_load_dwordx4 v224, s[20:23], s8 offen lds
    v_mfma_f32_16x16x32_bf16 v[104:107], a[56:59], v[152:155], v[104:107]
    ds_read_b64_tr_b16 a[100:101], v231 offset:49152
    s_add_u32 s9, s54, s7
    v_mfma_f32_16x16x32_bf16 v[108:111], a[60:63], v[152:155], v[108:111]
    ds_read_b64_tr_b16 a[102:103], v231 offset:49408
    v_mfma_f32_16x16x32_bf16 v[112:115], a[48:51], v[156:159], v[112:115]
    ds_read_b128 v[136:139], v245 offset:8192
    v_mfma_f32_16x16x32_bf16 v[116:119], a[52:55], v[156:159], v[116:119]
    buffer_load_dwordx4 v225, s[20:23], s8 offen offset:1024 lds
    v_mfma_f32_16x16x32_bf16 v[120:123], a[56:59], v[156:159], v[120:123]
    ds_read_b64_tr_b16 a[112:113], v230 offset:53248
    s_xor_b32 m0, s98, 49152
    v_mfma_f32_16x16x32_bf16 v[124:127], a[60:63], v[156:159], v[124:127]
    ds_read_b64_tr_b16 a[114:115], v230 offset:53504
    s_waitcnt lgkmcnt(12)
    v_mfma_f32_16x16x32_bf16 v[0:3], a[64:67], v[160:163], v[0:3]
    ds_read_b128 v[140:143], v245 offset:10240
    v_mfma_f32_16x16x32_bf16 v[4:7], a[68:71], v[160:163], v[4:7]
    buffer_load_dwordx4 v224, s[20:23], s9 offen lds
    v_mfma_f32_16x16x32_bf16 v[8:11], a[72:75], v[160:163], v[8:11]
    ds_read_b64_tr_b16 a[116:117], v231 offset:53248
    s_add_u32 s8, s53, s7
    v_mfma_f32_16x16x32_bf16 v[12:15], a[76:79], v[160:163], v[12:15]
    ds_read_b64_tr_b16 a[118:119], v231 offset:53504
    s_waitcnt lgkmcnt(14)
    v_mfma_f32_16x16x32_bf16 v[16:19], a[64:67], v[164:167], v[16:19]
    ds_read_b128 v[144:147], v244 offset:16384
    v_mfma_f32_16x16x32_bf16 v[20:23], a[68:71], v[164:167], v[20:23]
    buffer_load_dwordx4 v225, s[20:23], s9 offen offset:1024 lds
    v_mfma_f32_16x16x32_bf16 v[24:27], a[72:75], v[164:167], v[24:27]
    ds_read_b64_tr_b16 a[104:105], v232 offset:16384
    s_xor_b32 m0, s98, 40960
    v_mfma_f32_16x16x32_bf16 v[28:31], a[76:79], v[164:167], v[28:31]
    ds_read_b64_tr_b16 a[106:107], v232 offset:16640
    s_waitcnt lgkmcnt(15)
    v_mfma_f32_16x16x32_bf16 v[0:3], a[80:83], v[168:171], v[0:3]
    ds_read_b128 v[148:151], v244 offset:18432
    v_mfma_f32_16x16x32_bf16 v[4:7], a[84:87], v[168:171], v[4:7]
    buffer_load_dwordx4 v224, s[20:23], s8 offen lds
    v_mfma_f32_16x16x32_bf16 v[8:11], a[88:91], v[168:171], v[8:11]
    ds_read_b64_tr_b16 a[108:109], v233 offset:16384
    s_add_u32 s9, s55, s7
    v_mfma_f32_16x16x32_bf16 v[12:15], a[92:95], v[168:171], v[12:15]
    ds_read_b64_tr_b16 a[110:111], v233 offset:16640
    v_mfma_f32_16x16x32_bf16 v[16:19], a[80:83], v[172:175], v[16:19]
    ds_read_b128 v[152:155], v245 offset:16384
    v_mfma_f32_16x16x32_bf16 v[20:23], a[84:87], v[172:175], v[20:23]
    buffer_load_dwordx4 v225, s[20:23], s8 offen offset:1024 lds
    v_mfma_f32_16x16x32_bf16 v[24:27], a[88:91], v[172:175], v[24:27]
    ds_read_b64_tr_b16 a[120:121], v232 offset:20480
    s_xor_b32 m0, s98, 57344
    v_mfma_f32_16x16x32_bf16 v[28:31], a[92:95], v[172:175], v[28:31]
    ds_read_b64_tr_b16 a[122:123], v232 offset:20736
    s_waitcnt lgkmcnt(15)
    v_mfma_f32_16x16x32_bf16 v[32:35], a[64:67], v[128:131], v[32:35]
    ds_read_b128 v[156:159], v245 offset:18432
    v_mfma_f32_16x16x32_bf16 v[36:39], a[68:71], v[128:131], v[36:39]
    buffer_load_dwordx4 v224, s[20:23], s9 offen lds
    v_mfma_f32_16x16x32_bf16 v[40:43], a[72:75], v[128:131], v[40:43]
    ds_read_b64_tr_b16 a[124:125], v233 offset:20480
    s_bfe_u32 s6, s74, 0x40014
    v_mfma_f32_16x16x32_bf16 v[44:47], a[76:79], v[128:131], v[44:47]
    ds_read_b64_tr_b16 a[126:127], v233 offset:20736
    s_mul_i32 s5, s6, 458752
    v_mfma_f32_16x16x32_bf16 v[48:51], a[64:67], v[132:135], v[48:51]
    ds_read_b128 v[160:163], v244 offset:24576
    v_mfma_f32_16x16x32_bf16 v[52:55], a[68:71], v[132:135], v[52:55]
    buffer_load_dwordx4 v225, s[20:23], s9 offen offset:1024 lds
    v_mfma_f32_16x16x32_bf16 v[56:59], a[72:75], v[132:135], v[56:59]
    s_add_u32 m0, s56, 131072
    v_mfma_f32_16x16x32_bf16 v[60:63], a[76:79], v[132:135], v[60:63]
    s_waitcnt lgkmcnt(15)
    v_mfma_f32_16x16x32_bf16 v[32:35], a[80:83], v[136:139], v[32:35]
    ds_read_b128 v[164:167], v244 offset:26624
    v_mfma_f32_16x16x32_bf16 v[36:39], a[84:87], v[136:139], v[36:39]
    buffer_load_dwordx4 v226, s[24:27], s5 offen lds
    v_mfma_f32_16x16x32_bf16 v[40:43], a[88:91], v[136:139], v[40:43]
    s_add_u32 m0, s56, 132096
    v_mfma_f32_16x16x32_bf16 v[44:47], a[92:95], v[136:139], v[44:47]
    v_mfma_f32_16x16x32_bf16 v[48:51], a[80:83], v[140:143], v[48:51]
    ds_read_b128 v[168:171], v245 offset:24576
    v_mfma_f32_16x16x32_bf16 v[52:55], a[84:87], v[140:143], v[52:55]
    buffer_load_dwordx4 v227, s[24:27], s5 offen lds
    v_mfma_f32_16x16x32_bf16 v[56:59], a[88:91], v[140:143], v[56:59]
    s_add_u32 m0, s56, 98304
    v_mfma_f32_16x16x32_bf16 v[60:63], a[92:95], v[140:143], v[60:63]
    s_waitcnt lgkmcnt(14)
    v_mfma_f32_16x16x32_bf16 v[64:67], a[64:67], v[144:147], v[64:67]
    ds_read_b128 v[172:175], v245 offset:26624
    v_mfma_f32_16x16x32_bf16 v[68:71], a[68:71], v[144:147], v[68:71]
    buffer_load_dwordx4 v226, s[28:31], s5 offen lds
    v_mfma_f32_16x16x32_bf16 v[72:75], a[72:75], v[144:147], v[72:75]
    s_add_u32 m0, s56, 99328
    v_mfma_f32_16x16x32_bf16 v[76:79], a[76:79], v[144:147], v[76:79]
    s_waitcnt lgkmcnt(12)
    v_mfma_f32_16x16x32_bf16 v[80:83], a[64:67], v[148:151], v[80:83]
    v_mfma_f32_16x16x32_bf16 v[84:87], a[68:71], v[148:151], v[84:87]
    buffer_load_dwordx4 v227, s[28:31], s5 offen lds
    v_mfma_f32_16x16x32_bf16 v[88:91], a[72:75], v[148:151], v[88:91]
    v_mfma_f32_16x16x32_bf16 v[92:95], a[76:79], v[148:151], v[92:95]
    s_waitcnt lgkmcnt(9)
    v_mfma_f32_16x16x32_bf16 v[64:67], a[80:83], v[152:155], v[64:67]
    v_mfma_f32_16x16x32_bf16 v[68:71], a[84:87], v[152:155], v[68:71]
    v_mfma_f32_16x16x32_bf16 v[72:75], a[88:91], v[152:155], v[72:75]
    v_mfma_f32_16x16x32_bf16 v[76:79], a[92:95], v[152:155], v[76:79]
    s_waitcnt lgkmcnt(6)
    v_mfma_f32_16x16x32_bf16 v[80:83], a[80:83], v[156:159], v[80:83]
    v_mfma_f32_16x16x32_bf16 v[84:87], a[84:87], v[156:159], v[84:87]
    v_mfma_f32_16x16x32_bf16 v[88:91], a[88:91], v[156:159], v[88:91]
    v_mfma_f32_16x16x32_bf16 v[92:95], a[92:95], v[156:159], v[92:95]
    s_waitcnt lgkmcnt(3)
    v_mfma_f32_16x16x32_bf16 v[96:99], a[64:67], v[160:163], v[96:99]
    s_waitcnt vmcnt(12) lgkmcnt(0)
    s_barrier
    ds_read_b128 v[128:131], v242 offset:0
    s_bfe_u32 s7, s74, 0x40014
    v_mfma_f32_16x16x32_bf16 v[100:103], a[68:71], v[160:163], v[100:103]
    ds_read_b128 v[132:135], v242 offset:2048
    s_lshl_b32 s7, s7, 7
    v_mfma_f32_16x16x32_bf16 v[104:107], a[72:75], v[160:163], v[104:107]
    ds_read_b128 v[136:139], v243 offset:0
    s_add_u32 s8, s52, s7
    v_mfma_f32_16x16x32_bf16 v[108:111], a[76:79], v[160:163], v[108:111]
    ds_read_b128 v[140:143], v243 offset:2048
    s_xor_b32 m0, s98, 65536
    v_mfma_f32_16x16x32_bf16 v[112:115], a[64:67], v[164:167], v[112:115]
    ds_read_b128 v[144:147], v242 offset:8192
    v_mfma_f32_16x16x32_bf16 v[116:119], a[68:71], v[164:167], v[116:119]
    buffer_load_dwordx4 v224, s[20:23], s8 offen lds
    v_mfma_f32_16x16x32_bf16 v[120:123], a[72:75], v[164:167], v[120:123]
    ds_read_b64_tr_b16 a[128:129], v232 offset:24576
    s_add_u32 s9, s54, s7
    v_mfma_f32_16x16x32_bf16 v[124:127], a[76:79], v[164:167], v[124:127]
    ds_read_b64_tr_b16 a[130:131], v232 offset:24832
    v_mfma_f32_16x16x32_bf16 v[96:99], a[80:83], v[168:171], v[96:99]
    ds_read_b128 v[148:151], v242 offset:10240
    v_mfma_f32_16x16x32_bf16 v[100:103], a[84:87], v[168:171], v[100:103]
    buffer_load_dwordx4 v225, s[20:23], s8 offen offset:1024 lds
    v_mfma_f32_16x16x32_bf16 v[104:107], a[88:91], v[168:171], v[104:107]
    ds_read_b64_tr_b16 a[132:133], v233 offset:24576
    s_xor_b32 m0, s98, 81920
    v_mfma_f32_16x16x32_bf16 v[108:111], a[92:95], v[168:171], v[108:111]
    ds_read_b64_tr_b16 a[134:135], v233 offset:24832
    v_mfma_f32_16x16x32_bf16 v[112:115], a[80:83], v[172:175], v[112:115]
    ds_read_b128 v[152:155], v243 offset:8192
    v_mfma_f32_16x16x32_bf16 v[116:119], a[84:87], v[172:175], v[116:119]
    buffer_load_dwordx4 v224, s[20:23], s9 offen lds
    v_mfma_f32_16x16x32_bf16 v[120:123], a[88:91], v[172:175], v[120:123]
    ds_read_b64_tr_b16 a[144:145], v232 offset:28672
    s_add_u32 s8, s53, s7
    v_mfma_f32_16x16x32_bf16 v[124:127], a[92:95], v[172:175], v[124:127]
    ds_read_b64_tr_b16 a[146:147], v232 offset:28928
    s_waitcnt lgkmcnt(12)
    v_mfma_f32_16x16x32_bf16 v[0:3], a[96:99], v[128:131], v[0:3]
    ds_read_b128 v[156:159], v243 offset:10240
    v_mfma_f32_16x16x32_bf16 v[4:7], a[100:103], v[128:131], v[4:7]
    buffer_load_dwordx4 v225, s[20:23], s9 offen offset:1024 lds
    v_mfma_f32_16x16x32_bf16 v[8:11], a[104:107], v[128:131], v[8:11]
    ds_read_b64_tr_b16 a[148:149], v233 offset:28672
    s_xor_b32 m0, s98, 73728
    v_mfma_f32_16x16x32_bf16 v[12:15], a[108:111], v[128:131], v[12:15]
    ds_read_b64_tr_b16 a[150:151], v233 offset:28928
    s_waitcnt lgkmcnt(14)
    v_mfma_f32_16x16x32_bf16 v[16:19], a[96:99], v[132:135], v[16:19]
    ds_read_b128 v[160:163], v242 offset:16384
    v_mfma_f32_16x16x32_bf16 v[20:23], a[100:103], v[132:135], v[20:23]
    buffer_load_dwordx4 v224, s[20:23], s8 offen lds
    v_mfma_f32_16x16x32_bf16 v[24:27], a[104:107], v[132:135], v[24:27]
    ds_read_b64_tr_b16 a[136:137], v230 offset:57344
    s_add_u32 s9, s55, s7
    v_mfma_f32_16x16x32_bf16 v[28:31], a[108:111], v[132:135], v[28:31]
    ds_read_b64_tr_b16 a[138:139], v230 offset:57600
    s_waitcnt lgkmcnt(15)
    v_mfma_f32_16x16x32_bf16 v[0:3], a[112:115], v[136:139], v[0:3]
    ds_read_b128 v[164:167], v242 offset:18432
    v_mfma_f32_16x16x32_bf16 v[4:7], a[116:119], v[136:139], v[4:7]
    buffer_load_dwordx4 v225, s[20:23], s8 offen offset:1024 lds
    v_mfma_f32_16x16x32_bf16 v[8:11], a[120:123], v[136:139], v[8:11]
    ds_read_b64_tr_b16 a[140:141], v231 offset:57344
    s_xor_b32 m0, s98, 90112
    v_mfma_f32_16x16x32_bf16 v[12:15], a[124:127], v[136:139], v[12:15]
    ds_read_b64_tr_b16 a[142:143], v231 offset:57600
    v_mfma_f32_16x16x32_bf16 v[16:19], a[112:115], v[140:143], v[16:19]
    ds_read_b128 v[168:171], v243 offset:16384
    v_mfma_f32_16x16x32_bf16 v[20:23], a[116:119], v[140:143], v[20:23]
    buffer_load_dwordx4 v224, s[20:23], s9 offen lds
    v_mfma_f32_16x16x32_bf16 v[24:27], a[120:123], v[140:143], v[24:27]
    ds_read_b64_tr_b16 a[152:153], v230 offset:61440
    s_bfe_u32 s6, s74, 0x40018
    v_mfma_f32_16x16x32_bf16 v[28:31], a[124:127], v[140:143], v[28:31]
    ds_read_b64_tr_b16 a[154:155], v230 offset:61696
    s_waitcnt lgkmcnt(15)
    v_mfma_f32_16x16x32_bf16 v[32:35], a[96:99], v[144:147], v[32:35]
    ds_read_b128 v[172:175], v243 offset:18432
    s_mul_i32 s4, s6, 458752
    v_mfma_f32_16x16x32_bf16 v[36:39], a[100:103], v[144:147], v[36:39]
    buffer_load_dwordx4 v225, s[20:23], s9 offen offset:1024 lds
    v_mfma_f32_16x16x32_bf16 v[40:43], a[104:107], v[144:147], v[40:43]
    ds_read_b64_tr_b16 a[156:157], v231 offset:61440
    s_add_u32 m0, s56, 106496
    v_mfma_f32_16x16x32_bf16 v[44:47], a[108:111], v[144:147], v[44:47]
    ds_read_b64_tr_b16 a[158:159], v231 offset:61696
    v_mfma_f32_16x16x32_bf16 v[48:51], a[96:99], v[148:151], v[48:51]
    ds_read_b128 v[128:131], v242 offset:24576
    v_mfma_f32_16x16x32_bf16 v[52:55], a[100:103], v[148:151], v[52:55]
    buffer_load_dwordx4 v226, s[24:27], s4 offen lds
    v_mfma_f32_16x16x32_bf16 v[56:59], a[104:107], v[148:151], v[56:59]
    s_add_u32 m0, s56, 107520
    v_mfma_f32_16x16x32_bf16 v[60:63], a[108:111], v[148:151], v[60:63]
    s_waitcnt lgkmcnt(15)
    v_mfma_f32_16x16x32_bf16 v[32:35], a[112:115], v[152:155], v[32:35]
    ds_read_b128 v[132:135], v242 offset:26624
    v_mfma_f32_16x16x32_bf16 v[36:39], a[116:119], v[152:155], v[36:39]
    buffer_load_dwordx4 v227, s[24:27], s4 offen lds
    v_mfma_f32_16x16x32_bf16 v[40:43], a[120:123], v[152:155], v[40:43]
    s_add_u32 m0, s56, 139264
    v_mfma_f32_16x16x32_bf16 v[44:47], a[124:127], v[152:155], v[44:47]
    v_mfma_f32_16x16x32_bf16 v[48:51], a[112:115], v[156:159], v[48:51]
    ds_read_b128 v[136:139], v243 offset:24576
    v_mfma_f32_16x16x32_bf16 v[52:55], a[116:119], v[156:159], v[52:55]
    buffer_load_dwordx4 v226, s[28:31], s4 offen lds
    v_mfma_f32_16x16x32_bf16 v[56:59], a[120:123], v[156:159], v[56:59]
    s_add_u32 m0, s56, 140288
    s_bfe_u32 s10, s58, 0x40000
    s_lshl_b32 s10, s10, 17
    v_mfma_f32_16x16x32_bf16 v[60:63], a[124:127], v[156:159], v[60:63]
    s_add_u32 s10, s10, s69
    s_add_u32 s18, s10, 0
    s_waitcnt lgkmcnt(14)
    v_mfma_f32_16x16x32_bf16 v[64:67], a[96:99], v[160:163], v[64:67]
    ds_read_b128 v[140:143], v243 offset:26624
    v_mfma_f32_16x16x32_bf16 v[68:71], a[100:103], v[160:163], v[68:71]
    buffer_load_dwordx4 v227, s[28:31], s4 offen lds
    v_mfma_f32_16x16x32_bf16 v[72:75], a[104:107], v[160:163], v[72:75]
    s_add_u32 m0, s56, 114688
    v_mfma_f32_16x16x32_bf16 v[76:79], a[108:111], v[160:163], v[76:79]
    s_waitcnt lgkmcnt(12)
    v_mfma_f32_16x16x32_bf16 v[80:83], a[96:99], v[164:167], v[80:83]
    buffer_load_dwordx4 v234, s[32:35], s18 offen lds
    v_mfma_f32_16x16x32_bf16 v[84:87], a[100:103], v[164:167], v[84:87]
    v_mfma_f32_16x16x32_bf16 v[88:91], a[104:107], v[164:167], v[88:91]
    v_mfma_f32_16x16x32_bf16 v[92:95], a[108:111], v[164:167], v[92:95]
    s_waitcnt lgkmcnt(9)
    v_mfma_f32_16x16x32_bf16 v[64:67], a[112:115], v[168:171], v[64:67]
    buffer_load_dwordx4 v235, s[32:35], s18 offen offset:1024 lds
    v_mfma_f32_16x16x32_bf16 v[68:71], a[116:119], v[168:171], v[68:71]
    v_mfma_f32_16x16x32_bf16 v[72:75], a[120:123], v[168:171], v[72:75]
    v_mfma_f32_16x16x32_bf16 v[76:79], a[124:127], v[168:171], v[76:79]
    s_waitcnt lgkmcnt(6)
    v_mfma_f32_16x16x32_bf16 v[80:83], a[112:115], v[172:175], v[80:83]
    v_mfma_f32_16x16x32_bf16 v[84:87], a[116:119], v[172:175], v[84:87]
    v_mfma_f32_16x16x32_bf16 v[88:91], a[120:123], v[172:175], v[88:91]
    v_mfma_f32_16x16x32_bf16 v[92:95], a[124:127], v[172:175], v[92:95]
    s_waitcnt lgkmcnt(3)
    v_mfma_f32_16x16x32_bf16 v[96:99], a[96:99], v[128:131], v[96:99]
    s_waitcnt vmcnt(14) lgkmcnt(0)
    s_barrier
    ds_read_b128 v[144:147], v242 offset:32768
    s_bfe_u32 s7, s74, 0x40018
    v_mfma_f32_16x16x32_bf16 v[100:103], a[100:103], v[128:131], v[100:103]
    ds_read_b128 v[148:151], v242 offset:34816
    s_lshl_b32 s7, s7, 7
    v_mfma_f32_16x16x32_bf16 v[104:107], a[104:107], v[128:131], v[104:107]
    ds_read_b128 v[152:155], v243 offset:32768
    s_add_u32 s8, s52, s7
    v_mfma_f32_16x16x32_bf16 v[108:111], a[108:111], v[128:131], v[108:111]
    ds_read_b128 v[156:159], v243 offset:34816
    s_xor_b32 m0, s98, 0
    v_mfma_f32_16x16x32_bf16 v[112:115], a[96:99], v[132:135], v[112:115]
    ds_read_b128 v[160:163], v242 offset:40960
    v_mfma_f32_16x16x32_bf16 v[116:119], a[100:103], v[132:135], v[116:119]
    buffer_load_dwordx4 v224, s[20:23], s8 offen lds
    v_mfma_f32_16x16x32_bf16 v[120:123], a[104:107], v[132:135], v[120:123]
    ds_read_b64_tr_b16 a[160:161], v232 offset:0
    s_add_u32 s9, s54, s7
    v_mfma_f32_16x16x32_bf16 v[124:127], a[108:111], v[132:135], v[124:127]
    ds_read_b64_tr_b16 a[162:163], v232 offset:256
    v_mfma_f32_16x16x32_bf16 v[96:99], a[112:115], v[136:139], v[96:99]
    ds_read_b128 v[164:167], v242 offset:43008
    v_mfma_f32_16x16x32_bf16 v[100:103], a[116:119], v[136:139], v[100:103]
    buffer_load_dwordx4 v225, s[20:23], s8 offen offset:1024 lds
    v_mfma_f32_16x16x32_bf16 v[104:107], a[120:123], v[136:139], v[104:107]
    ds_read_b64_tr_b16 a[164:165], v233 offset:0
    s_xor_b32 m0, s98, 16384
    v_mfma_f32_16x16x32_bf16 v[108:111], a[124:127], v[136:139], v[108:111]
    ds_read_b64_tr_b16 a[166:167], v233 offset:256
    v_mfma_f32_16x16x32_bf16 v[112:115], a[112:115], v[140:143], v[112:115]
    ds_read_b128 v[168:171], v243 offset:40960
    v_mfma_f32_16x16x32_bf16 v[116:119], a[116:119], v[140:143], v[116:119]
    buffer_load_dwordx4 v224, s[20:23], s9 offen lds
    v_mfma_f32_16x16x32_bf16 v[120:123], a[120:123], v[140:143], v[120:123]
    ds_read_b64_tr_b16 a[176:177], v232 offset:4096
    s_add_u32 s8, s53, s7
    v_mfma_f32_16x16x32_bf16 v[124:127], a[124:127], v[140:143], v[124:127]
    ds_read_b64_tr_b16 a[178:179], v232 offset:4352
    s_waitcnt lgkmcnt(12)
    v_mfma_f32_16x16x32_bf16 v[0:3], a[128:131], v[144:147], v[0:3]
    ds_read_b128 v[172:175], v243 offset:43008
    v_mfma_f32_16x16x32_bf16 v[4:7], a[132:135], v[144:147], v[4:7]
    buffer_load_dwordx4 v225, s[20:23], s9 offen offset:1024 lds
    v_mfma_f32_16x16x32_bf16 v[8:11], a[136:139], v[144:147], v[8:11]
    ds_read_b64_tr_b16 a[180:181], v233 offset:4096
    s_xor_b32 m0, s98, 8192
    v_mfma_f32_16x16x32_bf16 v[12:15], a[140:143], v[144:147], v[12:15]
    ds_read_b64_tr_b16 a[182:183], v233 offset:4352
    s_waitcnt lgkmcnt(14)
    v_mfma_f32_16x16x32_bf16 v[16:19], a[128:131], v[148:151], v[16:19]
    ds_read_b128 v[128:131], v242 offset:49152
    v_mfma_f32_16x16x32_bf16 v[20:23], a[132:135], v[148:151], v[20:23]
    buffer_load_dwordx4 v224, s[20:23], s8 offen lds
    v_mfma_f32_16x16x32_bf16 v[24:27], a[136:139], v[148:151], v[24:27]
    ds_read_b64_tr_b16 a[168:169], v230 offset:32768
    s_add_u32 s9, s55, s7
    v_mfma_f32_16x16x32_bf16 v[28:31], a[140:143], v[148:151], v[28:31]
    ds_read_b64_tr_b16 a[170:171], v230 offset:33024
    s_waitcnt lgkmcnt(15)
    v_mfma_f32_16x16x32_bf16 v[0:3], a[144:147], v[152:155], v[0:3]
    ds_read_b128 v[132:135], v242 offset:51200
    v_mfma_f32_16x16x32_bf16 v[4:7], a[148:151], v[152:155], v[4:7]
    buffer_load_dwordx4 v225, s[20:23], s8 offen offset:1024 lds
    v_mfma_f32_16x16x32_bf16 v[8:11], a[152:155], v[152:155], v[8:11]
    ds_read_b64_tr_b16 a[172:173], v231 offset:32768
    s_xor_b32 m0, s98, 24576
    v_mfma_f32_16x16x32_bf16 v[12:15], a[156:159], v[152:155], v[12:15]
    ds_read_b64_tr_b16 a[174:175], v231 offset:33024
    v_mfma_f32_16x16x32_bf16 v[16:19], a[144:147], v[156:159], v[16:19]
    ds_read_b128 v[136:139], v243 offset:49152
    v_mfma_f32_16x16x32_bf16 v[20:23], a[148:151], v[156:159], v[20:23]
    buffer_load_dwordx4 v224, s[20:23], s9 offen lds
    v_mfma_f32_16x16x32_bf16 v[24:27], a[152:155], v[156:159], v[24:27]
    ds_read_b64_tr_b16 a[184:185], v230 offset:36864
    s_bfe_u32 s6, s74, 0x4001c
    v_mfma_f32_16x16x32_bf16 v[28:31], a[156:159], v[156:159], v[28:31]
    ds_read_b64_tr_b16 a[186:187], v230 offset:37120
    s_waitcnt lgkmcnt(15)
    v_mfma_f32_16x16x32_bf16 v[32:35], a[128:131], v[160:163], v[32:35]
    ds_read_b128 v[140:143], v243 offset:51200
    s_mul_i32 s5, s6, 458752
    v_mfma_f32_16x16x32_bf16 v[36:39], a[132:135], v[160:163], v[36:39]
    buffer_load_dwordx4 v225, s[20:23], s9 offen offset:1024 lds
    v_mfma_f32_16x16x32_bf16 v[40:43], a[136:139], v[160:163], v[40:43]
    ds_read_b64_tr_b16 a[188:189], v231 offset:36864
    s_add_u32 m0, s56, 122880
    v_mfma_f32_16x16x32_bf16 v[44:47], a[140:143], v[160:163], v[44:47]
    ds_read_b64_tr_b16 a[190:191], v231 offset:37120
    v_mfma_f32_16x16x32_bf16 v[48:51], a[128:131], v[164:167], v[48:51]
    ds_read_b128 v[144:147], v242 offset:57344
    v_mfma_f32_16x16x32_bf16 v[52:55], a[132:135], v[164:167], v[52:55]
    buffer_load_dwordx4 v226, s[24:27], s5 offen lds
    v_mfma_f32_16x16x32_bf16 v[56:59], a[136:139], v[164:167], v[56:59]
    s_add_u32 m0, s56, 123904
    v_mfma_f32_16x16x32_bf16 v[60:63], a[140:143], v[164:167], v[60:63]
    s_waitcnt lgkmcnt(15)
    v_mfma_f32_16x16x32_bf16 v[32:35], a[144:147], v[168:171], v[32:35]
    ds_read_b128 v[148:151], v242 offset:59392
    v_mfma_f32_16x16x32_bf16 v[36:39], a[148:151], v[168:171], v[36:39]
    buffer_load_dwordx4 v227, s[24:27], s5 offen lds
    v_mfma_f32_16x16x32_bf16 v[40:43], a[152:155], v[168:171], v[40:43]
    s_add_u32 m0, s56, 147456
    v_mfma_f32_16x16x32_bf16 v[44:47], a[156:159], v[168:171], v[44:47]
    v_mfma_f32_16x16x32_bf16 v[48:51], a[144:147], v[172:175], v[48:51]
    ds_read_b128 v[152:155], v243 offset:57344
    v_mfma_f32_16x16x32_bf16 v[52:55], a[148:151], v[172:175], v[52:55]
    buffer_load_dwordx4 v226, s[28:31], s5 offen lds
    v_mfma_f32_16x16x32_bf16 v[56:59], a[152:155], v[172:175], v[56:59]
    s_add_u32 m0, s56, 148480
    v_mfma_f32_16x16x32_bf16 v[60:63], a[156:159], v[172:175], v[60:63]
    s_waitcnt lgkmcnt(14)
    v_mfma_f32_16x16x32_bf16 v[64:67], a[128:131], v[128:131], v[64:67]
    ds_read_b128 v[156:159], v243 offset:59392
    v_mfma_f32_16x16x32_bf16 v[68:71], a[132:135], v[128:131], v[68:71]
    buffer_load_dwordx4 v227, s[28:31], s5 offen lds
    v_mfma_f32_16x16x32_bf16 v[72:75], a[136:139], v[128:131], v[72:75]
    v_mfma_f32_16x16x32_bf16 v[76:79], a[140:143], v[128:131], v[76:79]
    s_waitcnt vmcnt(12) lgkmcnt(12)
    v_mfma_f32_16x16x32_bf16 v[80:83], a[128:131], v[132:135], v[80:83]
    ds_read_b64_tr_b16 v[176:177], v238 offset:49152
    v_mfma_f32_16x16x32_bf16 v[84:87], a[132:135], v[132:135], v[84:87]
    ds_read_b64_tr_b16 v[178:179], v238 offset:50176
    v_mfma_f32_16x16x32_bf16 v[88:91], a[136:139], v[132:135], v[88:91]
    ds_read_b64_tr_b16 v[180:181], v239 offset:49152
    v_mfma_f32_16x16x32_bf16 v[92:95], a[140:143], v[132:135], v[92:95]
    ds_read_b64_tr_b16 v[182:183], v239 offset:50176
    s_waitcnt lgkmcnt(13)
    v_mfma_f32_16x16x32_bf16 v[64:67], a[144:147], v[136:139], v[64:67]
    v_mfma_f32_16x16x32_bf16 v[68:71], a[148:151], v[136:139], v[68:71]
    v_mfma_f32_16x16x32_bf16 v[72:75], a[152:155], v[136:139], v[72:75]
    v_mfma_f32_16x16x32_bf16 v[76:79], a[156:159], v[136:139], v[76:79]
    s_waitcnt lgkmcnt(10)
    v_mfma_f32_16x16x32_bf16 v[80:83], a[144:147], v[140:143], v[80:83]
    v_mfma_f32_16x16x32_bf16 v[84:87], a[148:151], v[140:143], v[84:87]
    v_mfma_f32_16x16x32_bf16 v[88:91], a[152:155], v[140:143], v[88:91]
    v_mfma_f32_16x16x32_bf16 v[92:95], a[156:159], v[140:143], v[92:95]
    s_waitcnt lgkmcnt(7)
    v_mfma_f32_16x16x32_bf16 v[96:99], a[128:131], v[144:147], v[96:99]
    s_waitcnt lgkmcnt(4)
    s_barrier
    ds_read_b128 v[160:163], v244 offset:0
    s_bfe_u32 s7, s74, 0x4001c
    v_mfma_f32_16x16x32_bf16 v[100:103], a[132:135], v[144:147], v[100:103]
    ds_read_b128 v[164:167], v244 offset:2048
    s_lshl_b32 s7, s7, 7
    v_mfma_f32_16x16x32_bf16 v[104:107], a[136:139], v[144:147], v[104:107]
    ds_read_b128 v[168:171], v245 offset:0
    s_add_u32 s8, s52, s7
    v_mfma_f32_16x16x32_bf16 v[108:111], a[140:143], v[144:147], v[108:111]
    ds_read_b128 v[172:175], v245 offset:2048
    s_waitcnt lgkmcnt(4)
    v_mfma_f32_16x16x32_bf16 v[112:115], a[128:131], v[148:151], v[112:115]
    ds_read_b128 v[128:131], v244 offset:8192
    s_xor_b32 m0, s98, 32768
    v_mfma_f32_16x16x32_bf16 v[116:119], a[132:135], v[148:151], v[116:119]
    buffer_load_dwordx4 v224, s[20:23], s8 offen lds
    v_mfma_f32_16x16x32_bf16 v[120:123], a[136:139], v[148:151], v[120:123]
    ds_read_b64_tr_b16 a[192:193], v230 offset:40960
    s_add_u32 s9, s54, s7
    v_mfma_f32_16x16x32_bf16 v[124:127], a[140:143], v[148:151], v[124:127]
    ds_read_b64_tr_b16 a[194:195], v230 offset:41216
    v_mfma_f32_16x16x32_bf16 v[96:99], a[144:147], v[152:155], v[96:99]
    ds_read_b128 v[132:135], v244 offset:10240
    v_mfma_f32_16x16x32_bf16 v[100:103], a[148:151], v[152:155], v[100:103]
    buffer_load_dwordx4 v225, s[20:23], s8 offen offset:1024 lds
    v_mfma_f32_16x16x32_bf16 v[104:107], a[152:155], v[152:155], v[104:107]
    ds_read_b64_tr_b16 a[196:197], v231 offset:40960
    s_xor_b32 m0, s98, 49152
    v_mfma_f32_16x16x32_bf16 v[108:111], a[156:159], v[152:155], v[108:111]
    ds_read_b64_tr_b16 a[198:199], v231 offset:41216
    v_mfma_f32_16x16x32_bf16 v[112:115], a[144:147], v[156:159], v[112:115]
    ds_read_b128 v[136:139], v245 offset:8192
    v_mfma_f32_16x16x32_bf16 v[116:119], a[148:151], v[156:159], v[116:119]
    buffer_load_dwordx4 v224, s[20:23], s9 offen lds
    v_mfma_f32_16x16x32_bf16 v[120:123], a[152:155], v[156:159], v[120:123]
    ds_read_b64_tr_b16 a[208:209], v230 offset:45056
    s_add_u32 s8, s53, s7
    v_mfma_f32_16x16x32_bf16 v[124:127], a[156:159], v[156:159], v[124:127]
    ds_read_b64_tr_b16 a[210:211], v230 offset:45312
    s_waitcnt lgkmcnt(12)
    v_mfma_f32_16x16x32_bf16 v[0:3], a[160:163], v[160:163], v[0:3]
    ds_read_b128 v[140:143], v245 offset:10240
    v_mfma_f32_16x16x32_bf16 v[4:7], a[164:167], v[160:163], v[4:7]
    buffer_load_dwordx4 v225, s[20:23], s9 offen offset:1024 lds
    v_mfma_f32_16x16x32_bf16 v[8:11], a[168:171], v[160:163], v[8:11]
    ds_read_b64_tr_b16 a[212:213], v231 offset:45056
    s_xor_b32 m0, s98, 40960
    v_mfma_f32_16x16x32_bf16 v[12:15], a[172:175], v[160:163], v[12:15]
    ds_read_b64_tr_b16 a[214:215], v231 offset:45312
    s_waitcnt lgkmcnt(14)
    v_mfma_f32_16x16x32_bf16 v[16:19], a[160:163], v[164:167], v[16:19]
    ds_read_b128 v[144:147], v244 offset:16384
    v_mfma_f32_16x16x32_bf16 v[20:23], a[164:167], v[164:167], v[20:23]
    buffer_load_dwordx4 v224, s[20:23], s8 offen lds
    v_mfma_f32_16x16x32_bf16 v[24:27], a[168:171], v[164:167], v[24:27]
    ds_read_b64_tr_b16 a[200:201], v232 offset:8192
    s_add_u32 s9, s55, s7
    v_mfma_f32_16x16x32_bf16 v[28:31], a[172:175], v[164:167], v[28:31]
    ds_read_b64_tr_b16 a[202:203], v232 offset:8448
    s_waitcnt lgkmcnt(15)
    v_mfma_f32_16x16x32_bf16 v[0:3], a[176:179], v[168:171], v[0:3]
    ds_read_b128 v[148:151], v244 offset:18432
    v_mfma_f32_16x16x32_bf16 v[4:7], a[180:183], v[168:171], v[4:7]
    buffer_load_dwordx4 v225, s[20:23], s8 offen offset:1024 lds
    v_mfma_f32_16x16x32_bf16 v[8:11], a[184:187], v[168:171], v[8:11]
    ds_read_b64_tr_b16 a[204:205], v233 offset:8192
    s_xor_b32 m0, s98, 57344
    v_mfma_f32_16x16x32_bf16 v[12:15], a[188:191], v[168:171], v[12:15]
    ds_read_b64_tr_b16 a[206:207], v233 offset:8448
    v_mfma_f32_16x16x32_bf16 v[16:19], a[176:179], v[172:175], v[16:19]
    ds_read_b128 v[152:155], v245 offset:16384
    v_mfma_f32_16x16x32_bf16 v[20:23], a[180:183], v[172:175], v[20:23]
    buffer_load_dwordx4 v224, s[20:23], s9 offen lds
    v_mfma_f32_16x16x32_bf16 v[24:27], a[184:187], v[172:175], v[24:27]
    ds_read_b64_tr_b16 a[216:217], v232 offset:12288
    s_bfe_u32 s6, s75, 0x40000
    v_mfma_f32_16x16x32_bf16 v[28:31], a[188:191], v[172:175], v[28:31]
    ds_read_b64_tr_b16 a[218:219], v232 offset:12544
    s_waitcnt lgkmcnt(15)
    v_mfma_f32_16x16x32_bf16 v[32:35], a[160:163], v[128:131], v[32:35]
    ds_read_b128 v[156:159], v245 offset:18432
    s_mul_i32 s4, s6, 458752
    v_mfma_f32_16x16x32_bf16 v[36:39], a[164:167], v[128:131], v[36:39]
    buffer_load_dwordx4 v225, s[20:23], s9 offen offset:1024 lds
    v_mfma_f32_16x16x32_bf16 v[40:43], a[168:171], v[128:131], v[40:43]
    ds_read_b64_tr_b16 a[220:221], v233 offset:12288
    s_add_u32 m0, s56, 114688
    v_mfma_f32_16x16x32_bf16 v[44:47], a[172:175], v[128:131], v[44:47]
    ds_read_b64_tr_b16 a[222:223], v233 offset:12544
L_ST1:
    s_cbranch_execz L_ST5
L_D1_8:
    s_cbranch_execz L_DW1
    v_mfma_f32_16x16x32_bf16 v[48:51], a[160:163], v[132:135], v[48:51]
    ds_read_b128 v[160:163], v244 offset:24576
    v_mfma_f32_16x16x32_bf16 v[52:55], a[164:167], v[132:135], v[52:55]
    buffer_load_dwordx4 v226, s[24:27], s4 offen lds
    v_mfma_f32_16x16x32_bf16 v[56:59], a[168:171], v[132:135], v[56:59]
    s_add_u32 m0, s56, 115712
    v_mfma_f32_16x16x32_bf16 v[60:63], a[172:175], v[132:135], v[60:63]
    s_waitcnt lgkmcnt(15)
    v_mfma_f32_16x16x32_bf16 v[32:35], a[176:179], v[136:139], v[32:35]
    ds_read_b128 v[164:167], v244 offset:26624
    v_mfma_f32_16x16x32_bf16 v[36:39], a[180:183], v[136:139], v[36:39]
    buffer_load_dwordx4 v227, s[24:27], s4 offen lds
    v_mfma_f32_16x16x32_bf16 v[40:43], a[184:187], v[136:139], v[40:43]
    s_add_u32 m0, s56, 155648
    v_mfma_f32_16x16x32_bf16 v[44:47], a[188:191], v[136:139], v[44:47]
    v_mfma_f32_16x16x32_bf16 v[48:51], a[176:179], v[140:143], v[48:51]
    ds_read_b128 v[168:171], v245 offset:24576
    v_mfma_f32_16x16x32_bf16 v[52:55], a[180:183], v[140:143], v[52:55]
    buffer_load_dwordx4 v226, s[28:31], s4 offen lds
    v_mfma_f32_16x16x32_bf16 v[56:59], a[184:187], v[140:143], v[56:59]
    s_add_u32 m0, s56, 156672
    s_bfe_u32 s6, s75, 0x40010
    s_mul_i32 s5, s6, 458752
    v_mfma_f32_16x16x32_bf16 v[60:63], a[188:191], v[140:143], v[60:63]
    s_waitcnt lgkmcnt(14)
    v_mfma_f32_16x16x32_bf16 v[64:67], a[160:163], v[144:147], v[64:67]
    ds_read_b128 v[172:175], v245 offset:26624
    v_mfma_f32_16x16x32_bf16 v[68:71], a[164:167], v[144:147], v[68:71]
    buffer_load_dwordx4 v227, s[28:31], s4 offen lds
    v_mfma_f32_16x16x32_bf16 v[72:75], a[168:171], v[144:147], v[72:75]
    s_add_u32 m0, s56, 131072
    v_mfma_f32_16x16x32_bf16 v[76:79], a[172:175], v[144:147], v[76:79]
    s_waitcnt lgkmcnt(12)
    v_mfma_f32_16x16x32_bf16 v[80:83], a[160:163], v[148:151], v[80:83]
    buffer_load_dwordx4 v226, s[24:27], s5 offen lds
    v_mfma_f32_16x16x32_bf16 v[84:87], a[164:167], v[148:151], v[84:87]
    s_add_u32 m0, s56, 132096
    v_mfma_f32_16x16x32_bf16 v[88:91], a[168:171], v[148:151], v[88:91]
    v_mfma_f32_16x16x32_bf16 v[92:95], a[172:175], v[148:151], v[92:95]
    s_waitcnt lgkmcnt(9)
    v_mfma_f32_16x16x32_bf16 v[64:67], a[176:179], v[152:155], v[64:67]
    buffer_load_dwordx4 v227, s[24:27], s5 offen lds
    v_mfma_f32_16x16x32_bf16 v[68:71], a[180:183], v[152:155], v[68:71]
    v_mfma_f32_16x16x32_bf16 v[72:75], a[184:187], v[152:155], v[72:75]
    v_mfma_f32_16x16x32_bf16 v[76:79], a[188:191], v[152:155], v[76:79]
    s_waitcnt lgkmcnt(6)
    v_mfma_f32_16x16x32_bf16 v[80:83], a[176:179], v[156:159], v[80:83]
    v_mfma_f32_16x16x32_bf16 v[84:87], a[180:183], v[156:159], v[84:87]
    v_mfma_f32_16x16x32_bf16 v[88:91], a[184:187], v[156:159], v[88:91]
    v_mfma_f32_16x16x32_bf16 v[92:95], a[188:191], v[156:159], v[92:95]
    s_waitcnt lgkmcnt(3)
    v_mfma_f32_16x16x32_bf16 v[96:99], a[160:163], v[160:163], v[96:99]
    s_waitcnt vmcnt(14) lgkmcnt(0)
    s_barrier
    ds_read_b128 v[128:131], v242 offset:0
    s_bfe_u32 s7, s75, 0x40000
    v_mfma_f32_16x16x32_bf16 v[100:103], a[164:167], v[160:163], v[100:103]
    ds_read_b128 v[132:135], v242 offset:2048
    s_lshl_b32 s7, s7, 7
    v_mfma_f32_16x16x32_bf16 v[104:107], a[168:171], v[160:163], v[104:107]
    ds_read_b128 v[136:139], v243 offset:0
    s_add_u32 s8, s52, s7
    v_mfma_f32_16x16x32_bf16 v[108:111], a[172:175], v[160:163], v[108:111]
    ds_read_b128 v[140:143], v243 offset:2048
    s_xor_b32 m0, s98, 65536
    v_mfma_f32_16x16x32_bf16 v[112:115], a[160:163], v[164:167], v[112:115]
    ds_read_b128 v[144:147], v242 offset:8192
    v_mfma_f32_16x16x32_bf16 v[116:119], a[164:167], v[164:167], v[116:119]
    buffer_load_dwordx4 v224, s[20:23], s8 offen lds
    v_mfma_f32_16x16x32_bf16 v[120:123], a[168:171], v[164:167], v[120:123]
    ds_read_b64_tr_b16 a[224:225], v230 offset:57344
    s_add_u32 s9, s54, s7
    v_mfma_f32_16x16x32_bf16 v[124:127], a[172:175], v[164:167], v[124:127]
    ds_read_b64_tr_b16 a[226:227], v230 offset:57600
    v_mfma_f32_16x16x32_bf16 v[96:99], a[176:179], v[168:171], v[96:99]
    ds_read_b128 v[148:151], v242 offset:10240
    v_mfma_f32_16x16x32_bf16 v[100:103], a[180:183], v[168:171], v[100:103]
    buffer_load_dwordx4 v225, s[20:23], s8 offen offset:1024 lds
    v_mfma_f32_16x16x32_bf16 v[104:107], a[184:187], v[168:171], v[104:107]
    ds_read_b64_tr_b16 a[228:229], v231 offset:57344
    s_xor_b32 m0, s98, 81920
    v_mfma_f32_16x16x32_bf16 v[108:111], a[188:191], v[168:171], v[108:111]
    ds_read_b64_tr_b16 a[230:231], v231 offset:57600
    v_mfma_f32_16x16x32_bf16 v[112:115], a[176:179], v[172:175], v[112:115]
    ds_read_b128 v[152:155], v243 offset:8192
    v_mfma_f32_16x16x32_bf16 v[116:119], a[180:183], v[172:175], v[116:119]
    buffer_load_dwordx4 v224, s[20:23], s9 offen lds
    v_mfma_f32_16x16x32_bf16 v[120:123], a[184:187], v[172:175], v[120:123]
    ds_read_b64_tr_b16 a[240:241], v230 offset:61440
    s_add_u32 s8, s53, s7
    v_mfma_f32_16x16x32_bf16 v[124:127], a[188:191], v[172:175], v[124:127]
    ds_read_b64_tr_b16 a[242:243], v230 offset:61696
    s_waitcnt lgkmcnt(12)
    v_mfma_f32_16x16x32_bf16 v[0:3], a[192:195], v[128:131], v[0:3]
    ds_read_b128 v[156:159], v243 offset:10240
    v_mfma_f32_16x16x32_bf16 v[4:7], a[196:199], v[128:131], v[4:7]
    buffer_load_dwordx4 v225, s[20:23], s9 offen offset:1024 lds
    v_mfma_f32_16x16x32_bf16 v[8:11], a[200:203], v[128:131], v[8:11]
    ds_read_b64_tr_b16 a[244:245], v231 offset:61440
    s_xor_b32 m0, s98, 73728
    v_mfma_f32_16x16x32_bf16 v[12:15], a[204:207], v[128:131], v[12:15]
    ds_read_b64_tr_b16 a[246:247], v231 offset:61696
    s_waitcnt lgkmcnt(14)
    v_mfma_f32_16x16x32_bf16 v[16:19], a[192:195], v[132:135], v[16:19]
    ds_read_b128 v[160:163], v242 offset:16384
    v_mfma_f32_16x16x32_bf16 v[20:23], a[196:199], v[132:135], v[20:23]
    buffer_load_dwordx4 v224, s[20:23], s8 offen lds
    v_mfma_f32_16x16x32_bf16 v[24:27], a[200:203], v[132:135], v[24:27]
    ds_read_b64_tr_b16 a[232:233], v232 offset:16384
    s_add_u32 s9, s55, s7
    v_mfma_f32_16x16x32_bf16 v[28:31], a[204:207], v[132:135], v[28:31]
    ds_read_b64_tr_b16 a[234:235], v232 offset:16640
    s_waitcnt lgkmcnt(15)
    v_mfma_f32_16x16x32_bf16 v[0:3], a[208:211], v[136:139], v[0:3]
    ds_read_b128 v[164:167], v242 offset:18432
    v_mfma_f32_16x16x32_bf16 v[4:7], a[212:215], v[136:139], v[4:7]
    buffer_load_dwordx4 v225, s[20:23], s8 offen offset:1024 lds
    v_mfma_f32_16x16x32_bf16 v[8:11], a[216:219], v[136:139], v[8:11]
    ds_read_b64_tr_b16 a[236:237], v233 offset:16384
    s_xor_b32 m0, s98, 90112
    v_mfma_f32_16x16x32_bf16 v[12:15], a[220:223], v[136:139], v[12:15]
    ds_read_b64_tr_b16 a[238:239], v233 offset:16640
    v_mfma_f32_16x16x32_bf16 v[16:19], a[208:211], v[140:143], v[16:19]
    ds_read_b128 v[168:171], v243 offset:16384
    v_mfma_f32_16x16x32_bf16 v[20:23], a[212:215], v[140:143], v[20:23]
    buffer_load_dwordx4 v224, s[20:23], s9 offen lds
    v_mfma_f32_16x16x32_bf16 v[24:27], a[216:219], v[140:143], v[24:27]
    ds_read_b64_tr_b16 a[248:249], v232 offset:20480
    s_bfe_u32 s6, s75, 0x40004
    v_mfma_f32_16x16x32_bf16 v[28:31], a[220:223], v[140:143], v[28:31]
    ds_read_b64_tr_b16 a[250:251], v232 offset:20736
    s_waitcnt lgkmcnt(15)
    v_mfma_f32_16x16x32_bf16 v[32:35], a[192:195], v[144:147], v[32:35]
    ds_read_b128 v[172:175], v243 offset:18432
    s_mul_i32 s4, s6, 458752
    v_mfma_f32_16x16x32_bf16 v[36:39], a[196:199], v[144:147], v[36:39]
    buffer_load_dwordx4 v225, s[20:23], s9 offen offset:1024 lds
    v_mfma_f32_16x16x32_bf16 v[40:43], a[200:203], v[144:147], v[40:43]
    ds_read_b64_tr_b16 a[252:253], v233 offset:20480
    s_add_u32 m0, s56, 139264
    v_mfma_f32_16x16x32_bf16 v[44:47], a[204:207], v[144:147], v[44:47]
    ds_read_b64_tr_b16 a[254:255], v233 offset:20736
    v_mfma_f32_16x16x32_bf16 v[48:51], a[192:195], v[148:151], v[48:51]
    ds_read_b128 v[128:131], v242 offset:24576
    v_mfma_f32_16x16x32_bf16 v[52:55], a[196:199], v[148:151], v[52:55]
    buffer_load_dwordx4 v226, s[24:27], s4 offen lds
    v_mfma_f32_16x16x32_bf16 v[56:59], a[200:203], v[148:151], v[56:59]
    s_add_u32 m0, s56, 140288
    v_mfma_f32_16x16x32_bf16 v[60:63], a[204:207], v[148:151], v[60:63]
    s_waitcnt lgkmcnt(15)
    v_mfma_f32_16x16x32_bf16 v[32:35], a[208:211], v[152:155], v[32:35]
    ds_read_b128 v[132:135], v242 offset:26624
    v_mfma_f32_16x16x32_bf16 v[36:39], a[212:215], v[152:155], v[36:39]
    buffer_load_dwordx4 v227, s[24:27], s4 offen lds
    v_mfma_f32_16x16x32_bf16 v[40:43], a[216:219], v[152:155], v[40:43]
    s_add_u32 m0, s56, 98304
    v_mfma_f32_16x16x32_bf16 v[44:47], a[220:223], v[152:155], v[44:47]
    v_mfma_f32_16x16x32_bf16 v[48:51], a[208:211], v[156:159], v[48:51]
    ds_read_b128 v[136:139], v243 offset:24576
    v_mfma_f32_16x16x32_bf16 v[52:55], a[212:215], v[156:159], v[52:55]
    v_mfma_f32_16x16x32_bf16 v[56:59], a[216:219], v[156:159], v[56:59]
    v_mfma_f32_16x16x32_bf16 v[60:63], a[220:223], v[156:159], v[60:63]
    s_waitcnt lgkmcnt(14)
    v_mfma_f32_16x16x32_bf16 v[64:67], a[192:195], v[160:163], v[64:67]
    ds_read_b128 v[140:143], v243 offset:26624
    v_mfma_f32_16x16x32_bf16 v[68:71], a[196:199], v[160:163], v[68:71]
    v_mfma_f32_16x16x32_bf16 v[72:75], a[200:203], v[160:163], v[72:75]
    v_mfma_f32_16x16x32_bf16 v[76:79], a[204:207], v[160:163], v[76:79]
    s_waitcnt lgkmcnt(12)
    v_mfma_f32_16x16x32_bf16 v[80:83], a[192:195], v[164:167], v[80:83]
    v_mfma_f32_16x16x32_bf16 v[84:87], a[196:199], v[164:167], v[84:87]
    v_mfma_f32_16x16x32_bf16 v[88:91], a[200:203], v[164:167], v[88:91]
    buffer_load_dwordx4 v226, s[28:31], s4 offen lds
    v_mfma_f32_16x16x32_bf16 v[92:95], a[204:207], v[164:167], v[92:95]
    s_add_u32 m0, s56, 99328
    s_waitcnt lgkmcnt(9)
    v_mfma_f32_16x16x32_bf16 v[64:67], a[208:211], v[168:171], v[64:67]
    v_mfma_f32_16x16x32_bf16 v[68:71], a[212:215], v[168:171], v[68:71]
    v_mfma_f32_16x16x32_bf16 v[72:75], a[216:219], v[168:171], v[72:75]
    v_mfma_f32_16x16x32_bf16 v[76:79], a[220:223], v[168:171], v[76:79]
    s_waitcnt lgkmcnt(6)
    v_mfma_f32_16x16x32_bf16 v[80:83], a[208:211], v[172:175], v[80:83]
    buffer_load_dwordx4 v227, s[28:31], s4 offen lds
    v_mfma_f32_16x16x32_bf16 v[84:87], a[212:215], v[172:175], v[84:87]
    v_mfma_f32_16x16x32_bf16 v[88:91], a[216:219], v[172:175], v[88:91]
    v_mfma_f32_16x16x32_bf16 v[92:95], a[220:223], v[172:175], v[92:95]
    s_waitcnt lgkmcnt(3)
    v_mfma_f32_16x16x32_bf16 v[96:99], a[192:195], v[128:131], v[96:99]
    s_waitcnt vmcnt(14) lgkmcnt(0)
    s_barrier
    ds_read_b128 v[144:147], v242 offset:32768
    s_bfe_u32 s7, s75, 0x40004
    v_mfma_f32_16x16x32_bf16 v[100:103], a[196:199], v[128:131], v[100:103]
    ds_read_b128 v[148:151], v242 offset:34816
    s_lshl_b32 s7, s7, 7
    v_mfma_f32_16x16x32_bf16 v[104:107], a[200:203], v[128:131], v[104:107]
    ds_read_b128 v[152:155], v243 offset:32768
    s_add_u32 s8, s52, s7
    v_mfma_f32_16x16x32_bf16 v[108:111], a[204:207], v[128:131], v[108:111]
    ds_read_b128 v[156:159], v243 offset:34816
    s_xor_b32 m0, s98, 0
    v_mfma_f32_16x16x32_bf16 v[112:115], a[192:195], v[132:135], v[112:115]
    ds_read_b128 v[160:163], v242 offset:40960
    v_mfma_f32_16x16x32_bf16 v[116:119], a[196:199], v[132:135], v[116:119]
    buffer_load_dwordx4 v224, s[20:23], s8 offen lds
    v_mfma_f32_16x16x32_bf16 v[120:123], a[200:203], v[132:135], v[120:123]
    ds_read_b64_tr_b16 a[0:1], v230 offset:49152
    s_add_u32 s9, s54, s7
    v_mfma_f32_16x16x32_bf16 v[124:127], a[204:207], v[132:135], v[124:127]
    ds_read_b64_tr_b16 a[2:3], v230 offset:49408
    v_mfma_f32_16x16x32_bf16 v[96:99], a[208:211], v[136:139], v[96:99]
    ds_read_b128 v[164:167], v242 offset:43008
    v_mfma_f32_16x16x32_bf16 v[100:103], a[212:215], v[136:139], v[100:103]
    buffer_load_dwordx4 v225, s[20:23], s8 offen offset:1024 lds
    v_mfma_f32_16x16x32_bf16 v[104:107], a[216:219], v[136:139], v[104:107]
    ds_read_b64_tr_b16 a[4:5], v231 offset:49152
    s_xor_b32 m0, s98, 16384
    v_mfma_f32_16x16x32_bf16 v[108:111], a[220:223], v[136:139], v[108:111]
    ds_read_b64_tr_b16 a[6:7], v231 offset:49408
    v_mfma_f32_16x16x32_bf16 v[112:115], a[208:211], v[140:143], v[112:115]
    ds_read_b128 v[168:171], v243 offset:40960
    v_mfma_f32_16x16x32_bf16 v[116:119], a[212:215], v[140:143], v[116:119]
    buffer_load_dwordx4 v224, s[20:23], s9 offen lds
    v_mfma_f32_16x16x32_bf16 v[120:123], a[216:219], v[140:143], v[120:123]
    ds_read_b64_tr_b16 a[16:17], v230 offset:53248
    s_add_u32 s8, s53, s7
    v_mfma_f32_16x16x32_bf16 v[124:127], a[220:223], v[140:143], v[124:127]
    ds_read_b64_tr_b16 a[18:19], v230 offset:53504
    s_waitcnt lgkmcnt(12)
    v_mfma_f32_16x16x32_bf16 v[0:3], a[224:227], v[144:147], v[0:3]
    ds_read_b128 v[172:175], v243 offset:43008
    v_mfma_f32_16x16x32_bf16 v[4:7], a[228:231], v[144:147], v[4:7]
    buffer_load_dwordx4 v225, s[20:23], s9 offen offset:1024 lds
    v_mfma_f32_16x16x32_bf16 v[8:11], a[232:235], v[144:147], v[8:11]
    ds_read_b64_tr_b16 a[20:21], v231 offset:53248
    s_xor_b32 m0, s98, 8192
    v_mfma_f32_16x16x32_bf16 v[12:15], a[236:239], v[144:147], v[12:15]
    ds_read_b64_tr_b16 a[22:23], v231 offset:53504
    s_waitcnt lgkmcnt(14)
    v_mfma_f32_16x16x32_bf16 v[16:19], a[224:227], v[148:151], v[16:19]
    ds_read_b128 v[128:131], v242 offset:49152
    v_mfma_f32_16x16x32_bf16 v[20:23], a[228:231], v[148:151], v[20:23]
    buffer_load_dwordx4 v224, s[20:23], s8 offen lds
    v_mfma_f32_16x16x32_bf16 v[24:27], a[232:235], v[148:151], v[24:27]
    ds_read_b64_tr_b16 a[8:9], v232 offset:24576
    s_add_u32 s9, s55, s7
    v_mfma_f32_16x16x32_bf16 v[28:31], a[236:239], v[148:151], v[28:31]
    ds_read_b64_tr_b16 a[10:11], v232 offset:24832
    s_waitcnt lgkmcnt(15)
    v_mfma_f32_16x16x32_bf16 v[0:3], a[240:243], v[152:155], v[0:3]
    ds_read_b128 v[132:135], v242 offset:51200
    v_mfma_f32_16x16x32_bf16 v[4:7], a[244:247], v[152:155], v[4:7]
    buffer_load_dwordx4 v225, s[20:23], s8 offen offset:1024 lds
    v_mfma_f32_16x16x32_bf16 v[8:11], a[248:251], v[152:155], v[8:11]
    ds_read_b64_tr_b16 a[12:13], v233 offset:24576
    s_xor_b32 m0, s98, 24576
    v_mfma_f32_16x16x32_bf16 v[12:15], a[252:255], v[152:155], v[12:15]
    ds_read_b64_tr_b16 a[14:15], v233 offset:24832
    v_mfma_f32_16x16x32_bf16 v[16:19], a[240:243], v[156:159], v[16:19]
    ds_read_b128 v[136:139], v243 offset:49152
    v_mfma_f32_16x16x32_bf16 v[20:23], a[244:247], v[156:159], v[20:23]
    buffer_load_dwordx4 v224, s[20:23], s9 offen lds
    v_mfma_f32_16x16x32_bf16 v[24:27], a[248:251], v[156:159], v[24:27]
    ds_read_b64_tr_b16 a[24:25], v232 offset:28672
    s_bfe_u32 s6, s75, 0x40008
    v_mfma_f32_16x16x32_bf16 v[28:31], a[252:255], v[156:159], v[28:31]
    ds_read_b64_tr_b16 a[26:27], v232 offset:28928
    s_waitcnt lgkmcnt(15)
    v_mfma_f32_16x16x32_bf16 v[32:35], a[224:227], v[160:163], v[32:35]
    ds_read_b128 v[140:143], v243 offset:51200
    s_mul_i32 s5, s6, 458752
    v_mfma_f32_16x16x32_bf16 v[36:39], a[228:231], v[160:163], v[36:39]
    buffer_load_dwordx4 v225, s[20:23], s9 offen offset:1024 lds
    v_mfma_f32_16x16x32_bf16 v[40:43], a[232:235], v[160:163], v[40:43]
    ds_read_b64_tr_b16 a[28:29], v233 offset:28672
    s_add_u32 m0, s56, 106496
    v_mfma_f32_16x16x32_bf16 v[44:47], a[236:239], v[160:163], v[44:47]
    ds_read_b64_tr_b16 a[30:31], v233 offset:28928
    v_mfma_f32_16x16x32_bf16 v[48:51], a[224:227], v[164:167], v[48:51]
    ds_read_b128 v[144:147], v242 offset:57344
    v_mfma_f32_16x16x32_bf16 v[52:55], a[228:231], v[164:167], v[52:55]
    buffer_load_dwordx4 v226, s[24:27], s5 offen lds
    v_mfma_f32_16x16x32_bf16 v[56:59], a[232:235], v[164:167], v[56:59]
    s_add_u32 m0, s56, 107520
    v_mfma_f32_16x16x32_bf16 v[60:63], a[236:239], v[164:167], v[60:63]
    s_waitcnt lgkmcnt(15)
    v_mfma_f32_16x16x32_bf16 v[32:35], a[240:243], v[168:171], v[32:35]
    ds_read_b128 v[148:151], v242 offset:59392
    v_mfma_f32_16x16x32_bf16 v[36:39], a[244:247], v[168:171], v[36:39]
    buffer_load_dwordx4 v227, s[24:27], s5 offen lds
    v_mfma_f32_16x16x32_bf16 v[40:43], a[248:251], v[168:171], v[40:43]
    s_add_u32 m0, s56, 122880
    v_mfma_f32_16x16x32_bf16 v[44:47], a[252:255], v[168:171], v[44:47]
    v_mfma_f32_16x16x32_bf16 v[48:51], a[240:243], v[172:175], v[48:51]
    ds_read_b128 v[152:155], v243 offset:57344
    v_mfma_f32_16x16x32_bf16 v[52:55], a[244:247], v[172:175], v[52:55]
    buffer_load_dwordx4 v226, s[28:31], s5 offen lds
    v_mfma_f32_16x16x32_bf16 v[56:59], a[248:251], v[172:175], v[56:59]
    s_add_u32 m0, s56, 123904
    v_mfma_f32_16x16x32_bf16 v[60:63], a[252:255], v[172:175], v[60:63]
    s_waitcnt lgkmcnt(14)
    v_mfma_f32_16x16x32_bf16 v[64:67], a[224:227], v[128:131], v[64:67]
    ds_read_b128 v[156:159], v243 offset:59392
    s_load_dwordx2 s[96:97], s[40:41], 0
    v_mfma_f32_16x16x32_bf16 v[68:71], a[228:231], v[128:131], v[68:71]
    buffer_load_dwordx4 v227, s[28:31], s5 offen lds
    v_mfma_f32_16x16x32_bf16 v[72:75], a[232:235], v[128:131], v[72:75]
    v_mfma_f32_16x16x32_bf16 v[76:79], a[236:239], v[128:131], v[76:79]
    s_waitcnt lgkmcnt(12)
    v_mfma_f32_16x16x32_bf16 v[80:83], a[224:227], v[132:135], v[80:83]
    v_mfma_f32_16x16x32_bf16 v[84:87], a[228:231], v[132:135], v[84:87]
    v_mfma_f32_16x16x32_bf16 v[88:91], a[232:235], v[132:135], v[88:91]
    v_mfma_f32_16x16x32_bf16 v[92:95], a[236:239], v[132:135], v[92:95]
    s_waitcnt lgkmcnt(9)
    v_mfma_f32_16x16x32_bf16 v[64:67], a[240:243], v[136:139], v[64:67]
    v_mfma_f32_16x16x32_bf16 v[68:71], a[244:247], v[136:139], v[68:71]
    v_mfma_f32_16x16x32_bf16 v[72:75], a[248:251], v[136:139], v[72:75]
    v_mfma_f32_16x16x32_bf16 v[76:79], a[252:255], v[136:139], v[76:79]
    s_waitcnt lgkmcnt(6)
    v_mfma_f32_16x16x32_bf16 v[80:83], a[240:243], v[140:143], v[80:83]
    v_mfma_f32_16x16x32_bf16 v[84:87], a[244:247], v[140:143], v[84:87]
    v_mfma_f32_16x16x32_bf16 v[88:91], a[248:251], v[140:143], v[88:91]
    v_mfma_f32_16x16x32_bf16 v[92:95], a[252:255], v[140:143], v[92:95]
    s_waitcnt lgkmcnt(3)
    v_mfma_f32_16x16x32_bf16 v[96:99], a[224:227], v[144:147], v[96:99]
    s_waitcnt vmcnt(12) lgkmcnt(0)
    s_barrier
    ds_read_b128 v[160:163], v244 offset:0
    s_bfe_u32 s7, s75, 0x40008
    v_mfma_f32_16x16x32_bf16 v[100:103], a[228:231], v[144:147], v[100:103]
    ds_read_b128 v[164:167], v244 offset:2048
    s_lshl_b32 s7, s7, 7
    v_mfma_f32_16x16x32_bf16 v[104:107], a[232:235], v[144:147], v[104:107]
    ds_read_b128 v[168:171], v245 offset:0
    s_add_u32 s8, s52, s7
    v_mfma_f32_16x16x32_bf16 v[108:111], a[236:239], v[144:147], v[108:111]
    ds_read_b128 v[172:175], v245 offset:2048
    s_xor_b32 m0, s98, 32768
    v_mfma_f32_16x16x32_bf16 v[112:115], a[224:227], v[148:151], v[112:115]
    ds_read_b128 v[128:131], v244 offset:8192
    v_mfma_f32_16x16x32_bf16 v[116:119], a[228:231], v[148:151], v[116:119]
    buffer_load_dwordx4 v224, s[20:23], s8 offen lds
    v_mfma_f32_16x16x32_bf16 v[120:123], a[232:235], v[148:151], v[120:123]
    ds_read_b64_tr_b16 a[128:129], v232 offset:0
    s_add_u32 s9, s54, s7
    v_mfma_f32_16x16x32_bf16 v[124:127], a[236:239], v[148:151], v[124:127]
    ds_read_b64_tr_b16 a[130:131], v232 offset:256
    v_mfma_f32_16x16x32_bf16 v[96:99], a[240:243], v[152:155], v[96:99]
    ds_read_b128 v[132:135], v244 offset:10240
    v_mfma_f32_16x16x32_bf16 v[100:103], a[244:247], v[152:155], v[100:103]
    buffer_load_dwordx4 v225, s[20:23], s8 offen offset:1024 lds
    v_mfma_f32_16x16x32_bf16 v[104:107], a[248:251], v[152:155], v[104:107]
    ds_read_b64_tr_b16 a[132:133], v233 offset:0
    s_xor_b32 m0, s98, 49152
    v_mfma_f32_16x16x32_bf16 v[108:111], a[252:255], v[152:155], v[108:111]
    ds_read_b64_tr_b16 a[134:135], v233 offset:256
    v_mfma_f32_16x16x32_bf16 v[112:115], a[240:243], v[156:159], v[112:115]
    ds_read_b128 v[136:139], v245 offset:8192
    v_mfma_f32_16x16x32_bf16 v[116:119], a[244:247], v[156:159], v[116:119]
    buffer_load_dwordx4 v224, s[20:23], s9 offen lds
    v_mfma_f32_16x16x32_bf16 v[120:123], a[248:251], v[156:159], v[120:123]
    ds_read_b64_tr_b16 a[144:145], v232 offset:4096
    s_add_u32 s8, s53, s7
    v_mfma_f32_16x16x32_bf16 v[124:127], a[252:255], v[156:159], v[124:127]
    ds_read_b64_tr_b16 a[146:147], v232 offset:4352
    s_waitcnt lgkmcnt(12)
    v_mfma_f32_16x16x32_bf16 v[0:3], a[0:3], v[160:163], v[0:3]
    ds_read_b128 v[140:143], v245 offset:10240
    v_mfma_f32_16x16x32_bf16 v[4:7], a[4:7], v[160:163], v[4:7]
    buffer_load_dwordx4 v225, s[20:23], s9 offen offset:1024 lds
    v_mfma_f32_16x16x32_bf16 v[8:11], a[8:11], v[160:163], v[8:11]
    ds_read_b64_tr_b16 a[148:149], v233 offset:4096
    s_xor_b32 m0, s98, 40960
    v_mfma_f32_16x16x32_bf16 v[12:15], a[12:15], v[160:163], v[12:15]
    ds_read_b64_tr_b16 a[150:151], v233 offset:4352
    s_waitcnt lgkmcnt(14)
    v_mfma_f32_16x16x32_bf16 v[16:19], a[0:3], v[164:167], v[16:19]
    ds_read_b128 v[144:147], v244 offset:16384
    v_mfma_f32_16x16x32_bf16 v[20:23], a[4:7], v[164:167], v[20:23]
    buffer_load_dwordx4 v224, s[20:23], s8 offen lds
    v_mfma_f32_16x16x32_bf16 v[24:27], a[8:11], v[164:167], v[24:27]
    ds_read_b64_tr_b16 a[32:33], v232 offset:8192
    s_add_u32 s9, s55, s7
    v_mfma_f32_16x16x32_bf16 v[28:31], a[12:15], v[164:167], v[28:31]
    ds_read_b64_tr_b16 a[34:35], v232 offset:8448
    s_waitcnt lgkmcnt(15)
    v_mfma_f32_16x16x32_bf16 v[0:3], a[16:19], v[168:171], v[0:3]
    ds_read_b128 v[148:151], v244 offset:18432
    v_mfma_f32_16x16x32_bf16 v[4:7], a[20:23], v[168:171], v[4:7]
    buffer_load_dwordx4 v225, s[20:23], s8 offen offset:1024 lds
    v_mfma_f32_16x16x32_bf16 v[8:11], a[24:27], v[168:171], v[8:11]
    ds_read_b64_tr_b16 a[36:37], v233 offset:8192
    s_xor_b32 m0, s98, 57344
    v_mfma_f32_16x16x32_bf16 v[12:15], a[28:31], v[168:171], v[12:15]
    ds_read_b64_tr_b16 a[38:39], v233 offset:8448
    v_mfma_f32_16x16x32_bf16 v[16:19], a[16:19], v[172:175], v[16:19]
    ds_read_b128 v[152:155], v245 offset:16384
    v_mfma_f32_16x16x32_bf16 v[20:23], a[20:23], v[172:175], v[20:23]
    buffer_load_dwordx4 v224, s[20:23], s9 offen lds
    v_mfma_f32_16x16x32_bf16 v[24:27], a[24:27], v[172:175], v[24:27]
    ds_read_b64_tr_b16 a[48:49], v232 offset:12288
    s_bfe_u32 s6, s75, 0x4000c
    v_mfma_f32_16x16x32_bf16 v[28:31], a[28:31], v[172:175], v[28:31]
    ds_read_b64_tr_b16 a[50:51], v232 offset:12544
    s_waitcnt lgkmcnt(15)
    v_mfma_f32_16x16x32_bf16 v[32:35], a[0:3], v[128:131], v[32:35]
    ds_read_b128 v[156:159], v245 offset:18432
    s_mul_i32 s4, s6, 458752
    v_mfma_f32_16x16x32_bf16 v[36:39], a[4:7], v[128:131], v[36:39]
    buffer_load_dwordx4 v225, s[20:23], s9 offen offset:1024 lds
    v_mfma_f32_16x16x32_bf16 v[40:43], a[8:11], v[128:131], v[40:43]
    ds_read_b64_tr_b16 a[52:53], v233 offset:12288
    s_add_u32 m0, s56, 114688
    v_mfma_f32_16x16x32_bf16 v[44:47], a[12:15], v[128:131], v[44:47]
    ds_read_b64_tr_b16 a[54:55], v233 offset:12544
    v_mfma_f32_16x16x32_bf16 v[48:51], a[0:3], v[132:135], v[48:51]
    ds_read_b128 v[160:163], v244 offset:24576
    v_mfma_f32_16x16x32_bf16 v[52:55], a[4:7], v[132:135], v[52:55]
    buffer_load_dwordx4 v226, s[24:27], s4 offen lds
    v_mfma_f32_16x16x32_bf16 v[56:59], a[8:11], v[132:135], v[56:59]
    ds_read_b64_tr_b16 a[40:41], v230 offset:32768
    s_add_u32 m0, s56, 115712
    v_mfma_f32_16x16x32_bf16 v[60:63], a[12:15], v[132:135], v[60:63]
    ds_read_b64_tr_b16 a[42:43], v230 offset:33024
    s_waitcnt lgkmcnt(15)
    v_mfma_f32_16x16x32_bf16 v[32:35], a[16:19], v[136:139], v[32:35]
    ds_read_b128 v[164:167], v244 offset:26624
    v_mfma_f32_16x16x32_bf16 v[36:39], a[20:23], v[136:139], v[36:39]
    buffer_load_dwordx4 v227, s[24:27], s4 offen lds
    v_mfma_f32_16x16x32_bf16 v[40:43], a[24:27], v[136:139], v[40:43]
    ds_read_b64_tr_b16 a[44:45], v231 offset:32768
    s_add_u32 m0, s56, 147456
    v_mfma_f32_16x16x32_bf16 v[44:47], a[28:31], v[136:139], v[44:47]
    ds_read_b64_tr_b16 a[46:47], v231 offset:33024
    v_mfma_f32_16x16x32_bf16 v[48:51], a[16:19], v[140:143], v[48:51]
    ds_read_b128 v[168:171], v245 offset:24576
    v_mfma_f32_16x16x32_bf16 v[52:55], a[20:23], v[140:143], v[52:55]
    buffer_load_dwordx4 v226, s[28:31], s4 offen lds
    v_mfma_f32_16x16x32_bf16 v[56:59], a[24:27], v[140:143], v[56:59]
    ds_read_b64_tr_b16 a[56:57], v230 offset:36864
    s_add_u32 m0, s56, 148480
    v_mfma_f32_16x16x32_bf16 v[60:63], a[28:31], v[140:143], v[60:63]
    ds_read_b64_tr_b16 a[58:59], v230 offset:37120
    s_waitcnt lgkmcnt(15)
    v_mfma_f32_16x16x32_bf16 v[64:67], a[0:3], v[144:147], v[64:67]
    ds_read_b128 v[172:175], v245 offset:26624
    v_mfma_f32_16x16x32_bf16 v[68:71], a[4:7], v[144:147], v[68:71]
    buffer_load_dwordx4 v227, s[28:31], s4 offen lds
    v_mfma_f32_16x16x32_bf16 v[72:75], a[8:11], v[144:147], v[72:75]
    ds_read_b64_tr_b16 a[60:61], v231 offset:36864
    v_mfma_f32_16x16x32_bf16 v[76:79], a[12:15], v[144:147], v[76:79]
    ds_read_b64_tr_b16 a[62:63], v231 offset:37120
    v_mfma_f32_16x16x32_bf16 v[80:83], a[0:3], v[148:151], v[80:83]
    v_mfma_f32_16x16x32_bf16 v[84:87], a[4:7], v[148:151], v[84:87]
    v_mfma_f32_16x16x32_bf16 v[88:91], a[8:11], v[148:151], v[88:91]
    v_mfma_f32_16x16x32_bf16 v[92:95], a[12:15], v[148:151], v[92:95]
    s_waitcnt lgkmcnt(15)
    v_mfma_f32_16x16x32_bf16 v[64:67], a[16:19], v[152:155], v[64:67]
    v_mfma_f32_16x16x32_bf16 v[68:71], a[20:23], v[152:155], v[68:71]
    v_mfma_f32_16x16x32_bf16 v[72:75], a[24:27], v[152:155], v[72:75]
    v_mfma_f32_16x16x32_bf16 v[76:79], a[28:31], v[152:155], v[76:79]
    s_waitcnt lgkmcnt(14)
    v_mfma_f32_16x16x32_bf16 v[80:83], a[16:19], v[156:159], v[80:83]
    v_mfma_f32_16x16x32_bf16 v[84:87], a[20:23], v[156:159], v[84:87]
    v_mfma_f32_16x16x32_bf16 v[88:91], a[24:27], v[156:159], v[88:91]
    v_mfma_f32_16x16x32_bf16 v[92:95], a[28:31], v[156:159], v[92:95]
    s_waitcnt lgkmcnt(11)
    v_mfma_f32_16x16x32_bf16 v[96:99], a[0:3], v[160:163], v[96:99]
    s_waitcnt vmcnt(12) lgkmcnt(0)
    s_barrier
    ds_read_b128 v[128:131], v242 offset:0
    s_bfe_u32 s7, s75, 0x4000c
    v_mfma_f32_16x16x32_bf16 v[100:103], a[4:7], v[160:163], v[100:103]
    ds_read_b128 v[132:135], v242 offset:2048
    s_lshl_b32 s7, s7, 7
    v_mfma_f32_16x16x32_bf16 v[104:107], a[8:11], v[160:163], v[104:107]
    ds_read_b128 v[136:139], v243 offset:0
    s_add_u32 s8, s52, s7
    v_mfma_f32_16x16x32_bf16 v[108:111], a[12:15], v[160:163], v[108:111]
    ds_read_b128 v[140:143], v243 offset:2048
    s_xor_b32 m0, s98, 65536
    v_mfma_f32_16x16x32_bf16 v[112:115], a[0:3], v[164:167], v[112:115]
    ds_read_b128 v[144:147], v242 offset:8192
    v_mfma_f32_16x16x32_bf16 v[116:119], a[4:7], v[164:167], v[116:119]
    buffer_load_dwordx4 v224, s[20:23], s8 offen lds
    v_mfma_f32_16x16x32_bf16 v[120:123], a[8:11], v[164:167], v[120:123]
    ds_read_b64_tr_b16 a[64:65], v230 offset:40960
    s_add_u32 s9, s54, s7
    v_mfma_f32_16x16x32_bf16 v[124:127], a[12:15], v[164:167], v[124:127]
    ds_read_b64_tr_b16 a[66:67], v230 offset:41216
    v_mfma_f32_16x16x32_bf16 v[96:99], a[16:19], v[168:171], v[96:99]
    ds_read_b128 v[148:151], v242 offset:10240
    v_mfma_f32_16x16x32_bf16 v[100:103], a[20:23], v[168:171], v[100:103]
    buffer_load_dwordx4 v225, s[20:23], s8 offen offset:1024 lds
    v_mfma_f32_16x16x32_bf16 v[104:107], a[24:27], v[168:171], v[104:107]
    ds_read_b64_tr_b16 a[68:69], v231 offset:40960
    s_xor_b32 m0, s98, 81920
    v_mfma_f32_16x16x32_bf16 v[108:111], a[28:31], v[168:171], v[108:111]
    ds_read_b64_tr_b16 a[70:71], v231 offset:41216
    v_mfma_f32_16x16x32_bf16 v[112:115], a[16:19], v[172:175], v[112:115]
    ds_read_b128 v[152:155], v243 offset:8192
    v_mfma_f32_16x16x32_bf16 v[116:119], a[20:23], v[172:175], v[116:119]
    buffer_load_dwordx4 v224, s[20:23], s9 offen lds
    v_mfma_f32_16x16x32_bf16 v[120:123], a[24:27], v[172:175], v[120:123]
    ds_read_b64_tr_b16 a[80:81], v230 offset:45056
    s_add_u32 s8, s53, s7
    v_mfma_f32_16x16x32_bf16 v[124:127], a[28:31], v[172:175], v[124:127]
    ds_read_b64_tr_b16 a[82:83], v230 offset:45312
    s_waitcnt lgkmcnt(12)
    v_mfma_f32_16x16x32_bf16 v[0:3], a[32:35], v[128:131], v[0:3]
    ds_read_b128 v[156:159], v243 offset:10240
    v_mfma_f32_16x16x32_bf16 v[4:7], a[36:39], v[128:131], v[4:7]
    buffer_load_dwordx4 v225, s[20:23], s9 offen offset:1024 lds
    v_mfma_f32_16x16x32_bf16 v[8:11], a[40:43], v[128:131], v[8:11]
    ds_read_b64_tr_b16 a[84:85], v231 offset:45056
    s_xor_b32 m0, s98, 73728
    v_mfma_f32_16x16x32_bf16 v[12:15], a[44:47], v[128:131], v[12:15]
    ds_read_b64_tr_b16 a[86:87], v231 offset:45312
    s_waitcnt lgkmcnt(14)
    v_mfma_f32_16x16x32_bf16 v[16:19], a[32:35], v[132:135], v[16:19]
    ds_read_b128 v[160:163], v242 offset:16384
    v_mfma_f32_16x16x32_bf16 v[20:23], a[36:39], v[132:135], v[20:23]
    buffer_load_dwordx4 v224, s[20:23], s8 offen lds
    v_mfma_f32_16x16x32_bf16 v[24:27], a[40:43], v[132:135], v[24:27]
    ds_read_b64_tr_b16 a[72:73], v230 offset:57344
    s_add_u32 s9, s55, s7
    v_mfma_f32_16x16x32_bf16 v[28:31], a[44:47], v[132:135], v[28:31]
    ds_read_b64_tr_b16 a[74:75], v230 offset:57600
    s_waitcnt lgkmcnt(15)
    v_mfma_f32_16x16x32_bf16 v[0:3], a[48:51], v[136:139], v[0:3]
    ds_read_b128 v[164:167], v242 offset:18432
    v_mfma_f32_16x16x32_bf16 v[4:7], a[52:55], v[136:139], v[4:7]
    buffer_load_dwordx4 v225, s[20:23], s8 offen offset:1024 lds
    v_mfma_f32_16x16x32_bf16 v[8:11], a[56:59], v[136:139], v[8:11]
    ds_read_b64_tr_b16 a[76:77], v231 offset:57344
    s_xor_b32 m0, s98, 90112
    v_mfma_f32_16x16x32_bf16 v[12:15], a[60:63], v[136:139], v[12:15]
    ds_read_b64_tr_b16 a[78:79], v231 offset:57600
    v_mfma_f32_16x16x32_bf16 v[16:19], a[48:51], v[140:143], v[16:19]
    ds_read_b128 v[168:171], v243 offset:16384
    v_mfma_f32_16x16x32_bf16 v[20:23], a[52:55], v[140:143], v[20:23]
    buffer_load_dwordx4 v224, s[20:23], s9 offen lds
    v_mfma_f32_16x16x32_bf16 v[24:27], a[56:59], v[140:143], v[24:27]
    ds_read_b64_tr_b16 a[88:89], v230 offset:61440
L_ST2:
    s_cbranch_execz L_ST6
L_D1_12:
    s_cbranch_execz L_DW1
    s_bfe_u32 s6, s75, 0x40010
    v_mfma_f32_16x16x32_bf16 v[28:31], a[60:63], v[140:143], v[28:31]
    ds_read_b64_tr_b16 a[90:91], v230 offset:61696
    s_waitcnt lgkmcnt(15)
    v_mfma_f32_16x16x32_bf16 v[32:35], a[32:35], v[144:147], v[32:35]
    ds_read_b128 v[172:175], v243 offset:18432
    s_mul_i32 s5, s6, 458752
    v_mfma_f32_16x16x32_bf16 v[36:39], a[36:39], v[144:147], v[36:39]
    buffer_load_dwordx4 v225, s[20:23], s9 offen offset:1024 lds
    v_mfma_f32_16x16x32_bf16 v[40:43], a[40:43], v[144:147], v[40:43]
    ds_read_b64_tr_b16 a[92:93], v231 offset:61440
    s_add_u32 m0, s56, 155648
    v_mfma_f32_16x16x32_bf16 v[44:47], a[44:47], v[144:147], v[44:47]
    ds_read_b64_tr_b16 a[94:95], v231 offset:61696
    v_mfma_f32_16x16x32_bf16 v[48:51], a[32:35], v[148:151], v[48:51]
    ds_read_b128 v[128:131], v242 offset:24576
    v_mfma_f32_16x16x32_bf16 v[52:55], a[36:39], v[148:151], v[52:55]
    buffer_load_dwordx4 v226, s[28:31], s5 offen lds
    v_mfma_f32_16x16x32_bf16 v[56:59], a[40:43], v[148:151], v[56:59]
    s_add_u32 m0, s56, 156672
    s_bfe_u32 s6, s75, 0x40014
    s_mul_i32 s4, s6, 458752
    v_mfma_f32_16x16x32_bf16 v[60:63], a[44:47], v[148:151], v[60:63]
    s_waitcnt lgkmcnt(15)
    v_mfma_f32_16x16x32_bf16 v[32:35], a[48:51], v[152:155], v[32:35]
    ds_read_b128 v[132:135], v242 offset:26624
    v_mfma_f32_16x16x32_bf16 v[36:39], a[52:55], v[152:155], v[36:39]
    buffer_load_dwordx4 v227, s[28:31], s5 offen lds
    v_mfma_f32_16x16x32_bf16 v[40:43], a[56:59], v[152:155], v[40:43]
    s_add_u32 m0, s56, 98304
    v_mfma_f32_16x16x32_bf16 v[44:47], a[60:63], v[152:155], v[44:47]
    v_mfma_f32_16x16x32_bf16 v[48:51], a[48:51], v[156:159], v[48:51]
    ds_read_b128 v[136:139], v243 offset:24576
    v_mfma_f32_16x16x32_bf16 v[52:55], a[52:55], v[156:159], v[52:55]
    buffer_load_dwordx4 v226, s[24:27], s4 offen lds
    v_mfma_f32_16x16x32_bf16 v[56:59], a[56:59], v[156:159], v[56:59]
    s_add_u32 m0, s56, 99328
    v_mfma_f32_16x16x32_bf16 v[60:63], a[60:63], v[156:159], v[60:63]
    s_waitcnt lgkmcnt(14)
    v_mfma_f32_16x16x32_bf16 v[64:67], a[32:35], v[160:163], v[64:67]
    ds_read_b128 v[140:143], v243 offset:26624
    v_mfma_f32_16x16x32_bf16 v[68:71], a[36:39], v[160:163], v[68:71]
    buffer_load_dwordx4 v227, s[24:27], s4 offen lds
    v_mfma_f32_16x16x32_bf16 v[72:75], a[40:43], v[160:163], v[72:75]
    s_add_u32 m0, s56, 131072
    v_mfma_f32_16x16x32_bf16 v[76:79], a[44:47], v[160:163], v[76:79]
    s_waitcnt lgkmcnt(12)
    v_mfma_f32_16x16x32_bf16 v[80:83], a[32:35], v[164:167], v[80:83]
    buffer_load_dwordx4 v226, s[28:31], s4 offen lds
    v_mfma_f32_16x16x32_bf16 v[84:87], a[36:39], v[164:167], v[84:87]
    s_add_u32 m0, s56, 132096
    v_mfma_f32_16x16x32_bf16 v[88:91], a[40:43], v[164:167], v[88:91]
    v_mfma_f32_16x16x32_bf16 v[92:95], a[44:47], v[164:167], v[92:95]
    s_waitcnt lgkmcnt(9)
    v_mfma_f32_16x16x32_bf16 v[64:67], a[48:51], v[168:171], v[64:67]
    buffer_load_dwordx4 v227, s[28:31], s4 offen lds
    v_mfma_f32_16x16x32_bf16 v[68:71], a[52:55], v[168:171], v[68:71]
    v_mfma_f32_16x16x32_bf16 v[72:75], a[56:59], v[168:171], v[72:75]
    v_mfma_f32_16x16x32_bf16 v[76:79], a[60:63], v[168:171], v[76:79]
    s_waitcnt lgkmcnt(6)
    v_mfma_f32_16x16x32_bf16 v[80:83], a[48:51], v[172:175], v[80:83]
    v_mfma_f32_16x16x32_bf16 v[84:87], a[52:55], v[172:175], v[84:87]
    v_mfma_f32_16x16x32_bf16 v[88:91], a[56:59], v[172:175], v[88:91]
    v_mfma_f32_16x16x32_bf16 v[92:95], a[60:63], v[172:175], v[92:95]
    s_waitcnt lgkmcnt(3)
    v_mfma_f32_16x16x32_bf16 v[96:99], a[32:35], v[128:131], v[96:99]
    s_waitcnt vmcnt(14) lgkmcnt(0)
    s_barrier
    ds_read_b128 v[144:147], v242 offset:32768
    s_bfe_u32 s6, s75, 0x40018
    v_mfma_f32_16x16x32_bf16 v[100:103], a[36:39], v[128:131], v[100:103]
    ds_read_b128 v[148:151], v242 offset:34816
    s_mul_i32 s5, s6, 458752
    v_mfma_f32_16x16x32_bf16 v[104:107], a[40:43], v[128:131], v[104:107]
    ds_read_b128 v[152:155], v243 offset:32768
    s_add_u32 m0, s56, 139264
    v_mfma_f32_16x16x32_bf16 v[108:111], a[44:47], v[128:131], v[108:111]
    ds_read_b128 v[156:159], v243 offset:34816
    v_mfma_f32_16x16x32_bf16 v[112:115], a[32:35], v[132:135], v[112:115]
    ds_read_b128 v[160:163], v242 offset:40960
    v_mfma_f32_16x16x32_bf16 v[116:119], a[36:39], v[132:135], v[116:119]
    buffer_load_dwordx4 v226, s[24:27], s5 offen lds
    v_mfma_f32_16x16x32_bf16 v[120:123], a[40:43], v[132:135], v[120:123]
    ds_read_b64_tr_b16 a[96:97], v230 offset:49152
    s_add_u32 m0, s56, 140288
    v_mfma_f32_16x16x32_bf16 v[124:127], a[44:47], v[132:135], v[124:127]
    ds_read_b64_tr_b16 a[98:99], v230 offset:49408
    v_mfma_f32_16x16x32_bf16 v[96:99], a[48:51], v[136:139], v[96:99]
    ds_read_b128 v[164:167], v242 offset:43008
    v_mfma_f32_16x16x32_bf16 v[100:103], a[52:55], v[136:139], v[100:103]
    buffer_load_dwordx4 v227, s[24:27], s5 offen lds
    v_mfma_f32_16x16x32_bf16 v[104:107], a[56:59], v[136:139], v[104:107]
    ds_read_b64_tr_b16 a[100:101], v231 offset:49152
    s_add_u32 m0, s56, 106496
    v_mfma_f32_16x16x32_bf16 v[108:111], a[60:63], v[136:139], v[108:111]
    ds_read_b64_tr_b16 a[102:103], v231 offset:49408
    v_mfma_f32_16x16x32_bf16 v[112:115], a[48:51], v[140:143], v[112:115]
    ds_read_b128 v[168:171], v243 offset:40960
    v_mfma_f32_16x16x32_bf16 v[116:119], a[52:55], v[140:143], v[116:119]
    buffer_load_dwordx4 v226, s[28:31], s5 offen lds
    v_mfma_f32_16x16x32_bf16 v[120:123], a[56:59], v[140:143], v[120:123]
    ds_read_b64_tr_b16 a[112:113], v230 offset:53248
    s_add_u32 m0, s56, 107520
    v_mfma_f32_16x16x32_bf16 v[124:127], a[60:63], v[140:143], v[124:127]
    ds_read_b64_tr_b16 a[114:115], v230 offset:53504
    s_waitcnt lgkmcnt(12)
    v_mfma_f32_16x16x32_bf16 v[0:3], a[64:67], v[144:147], v[0:3]
    ds_read_b128 v[172:175], v243 offset:43008
    s_bfe_u32 s6, s75, 0x4001c
    v_mfma_f32_16x16x32_bf16 v[4:7], a[68:71], v[144:147], v[4:7]
    buffer_load_dwordx4 v227, s[28:31], s5 offen lds
    v_mfma_f32_16x16x32_bf16 v[8:11], a[72:75], v[144:147], v[8:11]
    s_mul_i32 s4, s6, 458752
    s_add_u32 m0, s56, 122880
    v_mfma_f32_16x16x32_bf16 v[12:15], a[76:79], v[144:147], v[12:15]
    ds_read_b64_tr_b16 a[116:117], v231 offset:53248
    s_waitcnt lgkmcnt(13)
    v_mfma_f32_16x16x32_bf16 v[16:19], a[64:67], v[148:151], v[16:19]
    ds_read_b128 v[128:131], v242 offset:49152
    v_mfma_f32_16x16x32_bf16 v[20:23], a[68:71], v[148:151], v[20:23]
    buffer_load_dwordx4 v226, s[24:27], s4 offen lds
    v_mfma_f32_16x16x32_bf16 v[24:27], a[72:75], v[148:151], v[24:27]
    ds_read_b64_tr_b16 a[118:119], v231 offset:53504
    s_add_u32 m0, s56, 123904
    v_mfma_f32_16x16x32_bf16 v[28:31], a[76:79], v[148:151], v[28:31]
    ds_read_b64_tr_b16 a[104:105], v232 offset:16384
    s_waitcnt lgkmcnt(15)
    v_mfma_f32_16x16x32_bf16 v[0:3], a[80:83], v[152:155], v[0:3]
    ds_read_b128 v[132:135], v242 offset:51200
    v_mfma_f32_16x16x32_bf16 v[4:7], a[84:87], v[152:155], v[4:7]
    buffer_load_dwordx4 v227, s[24:27], s4 offen lds
    v_mfma_f32_16x16x32_bf16 v[8:11], a[88:91], v[152:155], v[8:11]
    ds_read_b64_tr_b16 a[106:107], v232 offset:16640
    s_add_u32 m0, s56, 0
    v_mfma_f32_16x16x32_bf16 v[12:15], a[92:95], v[152:155], v[12:15]
    ds_read_b64_tr_b16 a[108:109], v233 offset:16384
    s_waitcnt lgkmcnt(15)
    v_mfma_f32_16x16x32_bf16 v[16:19], a[80:83], v[156:159], v[16:19]
    ds_read_b128 v[136:139], v243 offset:49152
    v_mfma_f32_16x16x32_bf16 v[20:23], a[84:87], v[156:159], v[20:23]
    ds_read_b64_tr_b16 a[110:111], v233 offset:16640
    v_mfma_f32_16x16x32_bf16 v[24:27], a[88:91], v[156:159], v[24:27]
    ds_read_b64_tr_b16 a[120:121], v232 offset:20480
    v_mfma_f32_16x16x32_bf16 v[28:31], a[92:95], v[156:159], v[28:31]
    ds_read_b64_tr_b16 a[122:123], v232 offset:20736
    v_mfma_f32_16x16x32_bf16 v[32:35], a[64:67], v[160:163], v[32:35]
    ds_read_b128 v[140:143], v243 offset:51200
    v_mfma_f32_16x16x32_bf16 v[36:39], a[68:71], v[160:163], v[36:39]
    ds_read_b64_tr_b16 a[124:125], v233 offset:20480
    v_mfma_f32_16x16x32_bf16 v[40:43], a[72:75], v[160:163], v[40:43]
    ds_read_b64_tr_b16 a[126:127], v233 offset:20736
    v_mfma_f32_16x16x32_bf16 v[44:47], a[76:79], v[160:163], v[44:47]
    s_waitcnt lgkmcnt(15)
    v_mfma_f32_16x16x32_bf16 v[48:51], a[64:67], v[164:167], v[48:51]
    ds_read_b128 v[144:147], v242 offset:57344
    v_mfma_f32_16x16x32_bf16 v[52:55], a[68:71], v[164:167], v[52:55]
    buffer_load_dwordx4 v226, s[28:31], s4 offen lds
    v_mfma_f32_16x16x32_bf16 v[56:59], a[72:75], v[164:167], v[56:59]
    s_add_u32 m0, s56, 1024
    s_bfe_u32 s7, s75, 0x40010
    s_lshl_b32 s7, s7, 7
    v_mfma_f32_16x16x32_bf16 v[60:63], a[76:79], v[164:167], v[60:63]
    s_bitcmp1_b32 s98, 13
    s_cselect_b32 s51, s53, s52
    s_add_u32 s8, s51, s7
    v_mfma_f32_16x16x32_bf16 v[32:35], a[80:83], v[168:171], v[32:35]
    ds_read_b128 v[148:151], v242 offset:59392
    v_mfma_f32_16x16x32_bf16 v[36:39], a[84:87], v[168:171], v[36:39]
    buffer_load_dwordx4 v227, s[28:31], s4 offen lds
    v_mfma_f32_16x16x32_bf16 v[40:43], a[88:91], v[168:171], v[40:43]
    s_add_u32 m0, s56, 8192
    v_mfma_f32_16x16x32_bf16 v[44:47], a[92:95], v[168:171], v[44:47]
    s_waitcnt lgkmcnt(15)
    v_mfma_f32_16x16x32_bf16 v[48:51], a[80:83], v[172:175], v[48:51]
    ds_read_b128 v[152:155], v243 offset:57344
    v_mfma_f32_16x16x32_bf16 v[52:55], a[84:87], v[172:175], v[52:55]
    buffer_load_dwordx4 v224, s[20:23], s8 offen lds
    v_mfma_f32_16x16x32_bf16 v[56:59], a[88:91], v[172:175], v[56:59]
    s_bfe_u32 s7, s75, 0x40014
    s_lshl_b32 s7, s7, 7
    s_add_u32 s9, s51, s7
    v_mfma_f32_16x16x32_bf16 v[60:63], a[92:95], v[172:175], v[60:63]
    s_waitcnt lgkmcnt(15)
    v_mfma_f32_16x16x32_bf16 v[64:67], a[64:67], v[128:131], v[64:67]
    ds_read_b128 v[156:159], v243 offset:59392
    v_mfma_f32_16x16x32_bf16 v[68:71], a[68:71], v[128:131], v[68:71]
    v_mfma_f32_16x16x32_bf16 v[72:75], a[72:75], v[128:131], v[72:75]
    buffer_load_dwordx4 v225, s[20:23], s8 offen offset:1024 lds
    v_mfma_f32_16x16x32_bf16 v[76:79], a[76:79], v[128:131], v[76:79]
    s_add_u32 m0, s56, 16384
    s_waitcnt lgkmcnt(13)
    v_mfma_f32_16x16x32_bf16 v[80:83], a[64:67], v[132:135], v[80:83]
    v_mfma_f32_16x16x32_bf16 v[84:87], a[68:71], v[132:135], v[84:87]
    v_mfma_f32_16x16x32_bf16 v[88:91], a[72:75], v[132:135], v[88:91]
    buffer_load_dwordx4 v224, s[20:23], s9 offen lds
    v_mfma_f32_16x16x32_bf16 v[92:95], a[76:79], v[132:135], v[92:95]
    s_bfe_u32 s7, s75, 0x40018
    s_lshl_b32 s7, s7, 7
    s_waitcnt lgkmcnt(10)
    v_mfma_f32_16x16x32_bf16 v[64:67], a[80:83], v[136:139], v[64:67]
    s_add_u32 s8, s51, s7
    v_mfma_f32_16x16x32_bf16 v[68:71], a[84:87], v[136:139], v[68:71]
    v_mfma_f32_16x16x32_bf16 v[72:75], a[88:91], v[136:139], v[72:75]
    v_mfma_f32_16x16x32_bf16 v[76:79], a[92:95], v[136:139], v[76:79]
    s_waitcnt lgkmcnt(6)
    v_mfma_f32_16x16x32_bf16 v[80:83], a[80:83], v[140:143], v[80:83]
    buffer_load_dwordx4 v225, s[20:23], s9 offen offset:1024 lds
    v_mfma_f32_16x16x32_bf16 v[84:87], a[84:87], v[140:143], v[84:87]
    s_add_u32 m0, s56, 24576
    v_mfma_f32_16x16x32_bf16 v[88:91], a[88:91], v[140:143], v[88:91]
    v_mfma_f32_16x16x32_bf16 v[92:95], a[92:95], v[140:143], v[92:95]
    s_waitcnt lgkmcnt(3)
    v_mfma_f32_16x16x32_bf16 v[96:99], a[64:67], v[144:147], v[96:99]
    s_waitcnt vmcnt(12) lgkmcnt(0)
    s_barrier
    ds_read_b128 v[160:163], v244 offset:0
    v_mfma_f32_16x16x32_bf16 v[100:103], a[68:71], v[144:147], v[100:103]
    ds_read_b128 v[164:167], v244 offset:2048
    v_mfma_f32_16x16x32_bf16 v[104:107], a[72:75], v[144:147], v[104:107]
    ds_read_b128 v[168:171], v245 offset:0
    v_mfma_f32_16x16x32_bf16 v[108:111], a[76:79], v[144:147], v[108:111]
    ds_read_b128 v[172:175], v245 offset:2048
    v_mfma_f32_16x16x32_bf16 v[112:115], a[64:67], v[148:151], v[112:115]
    ds_read_b128 v[128:131], v244 offset:8192
    v_mfma_f32_16x16x32_bf16 v[116:119], a[68:71], v[148:151], v[116:119]
    buffer_load_dwordx4 v224, s[20:23], s8 offen lds
    v_mfma_f32_16x16x32_bf16 v[120:123], a[72:75], v[148:151], v[120:123]
    ds_read_b64_tr_b16 a[136:137], v232 offset:24576
    s_bfe_u32 s7, s75, 0x4001c
    v_mfma_f32_16x16x32_bf16 v[124:127], a[76:79], v[148:151], v[124:127]
    ds_read_b64_tr_b16 a[138:139], v232 offset:24832
    s_lshl_b32 s7, s7, 7
    v_mfma_f32_16x16x32_bf16 v[96:99], a[80:83], v[152:155], v[96:99]
    ds_read_b128 v[132:135], v244 offset:10240
    s_add_u32 s9, s51, s7
    v_mfma_f32_16x16x32_bf16 v[100:103], a[84:87], v[152:155], v[100:103]
    buffer_load_dwordx4 v225, s[20:23], s8 offen offset:1024 lds
    v_mfma_f32_16x16x32_bf16 v[104:107], a[88:91], v[152:155], v[104:107]
    ds_read_b64_tr_b16 a[140:141], v233 offset:24576
    s_add_u32 m0, s56, 114688
    v_mfma_f32_16x16x32_bf16 v[108:111], a[92:95], v[152:155], v[108:111]
    ds_read_b64_tr_b16 a[142:143], v233 offset:24832
    v_mfma_f32_16x16x32_bf16 v[112:115], a[80:83], v[156:159], v[112:115]
    ds_read_b128 v[136:139], v245 offset:8192
    v_mfma_f32_16x16x32_bf16 v[116:119], a[84:87], v[156:159], v[116:119]
    buffer_load_dwordx4 v224, s[20:23], s9 offen lds
    v_mfma_f32_16x16x32_bf16 v[120:123], a[88:91], v[156:159], v[120:123]
    ds_read_b64_tr_b16 a[152:153], v232 offset:28672
    s_add_u32 s19, s10, 65536
    v_mfma_f32_16x16x32_bf16 v[124:127], a[92:95], v[156:159], v[124:127]
    ds_read_b64_tr_b16 a[154:155], v232 offset:28928
    s_waitcnt lgkmcnt(12)
    v_mfma_f32_16x16x32_bf16 v[0:3], a[96:99], v[160:163], v[0:3]
    ds_read_b128 v[140:143], v245 offset:10240
    v_mfma_f32_16x16x32_bf16 v[4:7], a[100:103], v[160:163], v[4:7]
    buffer_load_dwordx4 v225, s[20:23], s9 offen offset:1024 lds
    v_mfma_f32_16x16x32_bf16 v[8:11], a[104:107], v[160:163], v[8:11]
    ds_read_b64_tr_b16 a[156:157], v233 offset:28672
    s_add_u32 m0, s56, 147456
    v_mfma_f32_16x16x32_bf16 v[12:15], a[108:111], v[160:163], v[12:15]
    ds_read_b64_tr_b16 a[158:159], v233 offset:28928
    s_waitcnt lgkmcnt(14)
    v_mfma_f32_16x16x32_bf16 v[16:19], a[96:99], v[164:167], v[16:19]
    ds_read_b128 v[144:147], v244 offset:16384
    v_mfma_f32_16x16x32_bf16 v[20:23], a[100:103], v[164:167], v[20:23]
    buffer_load_dwordx4 v234, s[32:35], s19 offen lds
    v_mfma_f32_16x16x32_bf16 v[24:27], a[104:107], v[164:167], v[24:27]
    ds_read_b64_tr_b16 a[160:161], v230 offset:32768
    s_add_u32 s18, s10, 917504
    v_mfma_f32_16x16x32_bf16 v[28:31], a[108:111], v[164:167], v[28:31]
    ds_read_b64_tr_b16 a[162:163], v230 offset:33024
    s_waitcnt lgkmcnt(15)
    v_mfma_f32_16x16x32_bf16 v[0:3], a[112:115], v[168:171], v[0:3]
    ds_read_b128 v[148:151], v244 offset:18432
    v_mfma_f32_16x16x32_bf16 v[4:7], a[116:119], v[168:171], v[4:7]
    buffer_load_dwordx4 v235, s[32:35], s19 offen offset:1024 lds
    v_mfma_f32_16x16x32_bf16 v[8:11], a[120:123], v[168:171], v[8:11]
    ds_read_b64_tr_b16 a[164:165], v231 offset:32768
    s_add_u32 m0, s56, 32768
    v_mfma_f32_16x16x32_bf16 v[12:15], a[124:127], v[168:171], v[12:15]
    ds_read_b64_tr_b16 a[166:167], v231 offset:33024
    v_mfma_f32_16x16x32_bf16 v[16:19], a[112:115], v[172:175], v[16:19]
    ds_read_b128 v[152:155], v245 offset:16384
    v_mfma_f32_16x16x32_bf16 v[20:23], a[116:119], v[172:175], v[20:23]
    buffer_load_dwordx4 v234, s[32:35], s18 offen lds
    v_mfma_f32_16x16x32_bf16 v[24:27], a[120:123], v[172:175], v[24:27]
    ds_read_b64_tr_b16 a[176:177], v230 offset:36864
    s_add_u32 s19, s10, 983040
    v_mfma_f32_16x16x32_bf16 v[28:31], a[124:127], v[172:175], v[28:31]
    ds_read_b64_tr_b16 a[178:179], v230 offset:37120
    s_waitcnt lgkmcnt(15)
    v_mfma_f32_16x16x32_bf16 v[32:35], a[96:99], v[128:131], v[32:35]
    ds_read_b128 v[156:159], v245 offset:18432
    v_mfma_f32_16x16x32_bf16 v[36:39], a[100:103], v[128:131], v[36:39]
    buffer_load_dwordx4 v235, s[32:35], s18 offen offset:1024 lds
    v_mfma_f32_16x16x32_bf16 v[40:43], a[104:107], v[128:131], v[40:43]
    ds_read_b64_tr_b16 a[180:181], v231 offset:36864
    s_add_u32 m0, s56, 40960
    v_mfma_f32_16x16x32_bf16 v[44:47], a[108:111], v[128:131], v[44:47]
    ds_read_b64_tr_b16 a[182:183], v231 offset:37120
    v_mfma_f32_16x16x32_bf16 v[48:51], a[96:99], v[132:135], v[48:51]
    ds_read_b128 v[160:163], v244 offset:24576
    v_mfma_f32_16x16x32_bf16 v[52:55], a[100:103], v[132:135], v[52:55]
    buffer_load_dwordx4 v234, s[32:35], s19 offen lds
    v_mfma_f32_16x16x32_bf16 v[56:59], a[104:107], v[132:135], v[56:59]
    ds_read_b64_tr_b16 a[168:169], v232 offset:0
    s_bfe_u32 s7, s75, 0x40010
    v_mfma_f32_16x16x32_bf16 v[60:63], a[108:111], v[132:135], v[60:63]
    ds_read_b64_tr_b16 a[170:171], v232 offset:256
    s_waitcnt lgkmcnt(15)
    v_mfma_f32_16x16x32_bf16 v[32:35], a[112:115], v[136:139], v[32:35]
    ds_read_b128 v[164:167], v244 offset:26624
    s_lshl_b32 s7, s7, 7
    v_mfma_f32_16x16x32_bf16 v[36:39], a[116:119], v[136:139], v[36:39]
    buffer_load_dwordx4 v235, s[32:35], s19 offen offset:1024 lds
    v_mfma_f32_16x16x32_bf16 v[40:43], a[120:123], v[136:139], v[40:43]
    s_bitcmp1_b32 s98, 13
    s_cselect_b32 s51, s52, s53
    s_add_u32 s8, s51, s7
    s_add_u32 m0, s56, 49152
    v_mfma_f32_16x16x32_bf16 v[44:47], a[124:127], v[136:139], v[44:47]
    ds_read_b64_tr_b16 a[172:173], v233 offset:0
    v_mfma_f32_16x16x32_bf16 v[48:51], a[112:115], v[140:143], v[48:51]
    ds_read_b128 v[168:171], v245 offset:24576
    v_mfma_f32_16x16x32_bf16 v[52:55], a[116:119], v[140:143], v[52:55]
    buffer_load_dwordx4 v224, s[20:23], s8 offen lds
    v_mfma_f32_16x16x32_bf16 v[56:59], a[120:123], v[140:143], v[56:59]
    ds_read_b64_tr_b16 a[174:175], v233 offset:256
    s_bfe_u32 s7, s75, 0x40014
    v_mfma_f32_16x16x32_bf16 v[60:63], a[124:127], v[140:143], v[60:63]
    ds_read_b64_tr_b16 a[184:185], v232 offset:4096
    s_waitcnt lgkmcnt(15)
    v_mfma_f32_16x16x32_bf16 v[64:67], a[96:99], v[144:147], v[64:67]
    ds_read_b128 v[172:175], v245 offset:26624
    s_lshl_b32 s7, s7, 7
    v_mfma_f32_16x16x32_bf16 v[68:71], a[100:103], v[144:147], v[68:71]
    buffer_load_dwordx4 v225, s[20:23], s8 offen offset:1024 lds
    v_mfma_f32_16x16x32_bf16 v[72:75], a[104:107], v[144:147], v[72:75]
    s_add_u32 s9, s51, s7
    s_add_u32 m0, s56, 57344
    v_mfma_f32_16x16x32_bf16 v[76:79], a[108:111], v[144:147], v[76:79]
    ds_read_b64_tr_b16 a[186:187], v232 offset:4352
    v_mfma_f32_16x16x32_bf16 v[80:83], a[96:99], v[148:151], v[80:83]
    buffer_load_dwordx4 v224, s[20:23], s9 offen lds
    v_mfma_f32_16x16x32_bf16 v[84:87], a[100:103], v[148:151], v[84:87]
    ds_read_b64_tr_b16 a[188:189], v233 offset:4096
    v_mfma_f32_16x16x32_bf16 v[88:91], a[104:107], v[148:151], v[88:91]
    ds_read_b64_tr_b16 a[190:191], v233 offset:4352
    v_mfma_f32_16x16x32_bf16 v[92:95], a[108:111], v[148:151], v[92:95]
    s_waitcnt lgkmcnt(15)
    v_mfma_f32_16x16x32_bf16 v[64:67], a[112:115], v[152:155], v[64:67]
    buffer_load_dwordx4 v225, s[20:23], s9 offen offset:1024 lds
    v_mfma_f32_16x16x32_bf16 v[68:71], a[116:119], v[152:155], v[68:71]
    v_mfma_f32_16x16x32_bf16 v[72:75], a[120:123], v[152:155], v[72:75]
    v_mfma_f32_16x16x32_bf16 v[76:79], a[124:127], v[152:155], v[76:79]
    s_waitcnt lgkmcnt(14)
    v_mfma_f32_16x16x32_bf16 v[80:83], a[112:115], v[156:159], v[80:83]
    v_mfma_f32_16x16x32_bf16 v[84:87], a[116:119], v[156:159], v[84:87]
    v_mfma_f32_16x16x32_bf16 v[88:91], a[120:123], v[156:159], v[88:91]
    v_mfma_f32_16x16x32_bf16 v[92:95], a[124:127], v[156:159], v[92:95]
    s_waitcnt lgkmcnt(11)
    v_mfma_f32_16x16x32_bf16 v[96:99], a[96:99], v[160:163], v[96:99]
    s_waitcnt vmcnt(10) lgkmcnt(0)
    s_barrier
    ds_read_b128 v[128:131], v242 offset:8192
    s_bfe_u32 s7, s75, 0x40018
    v_mfma_f32_16x16x32_bf16 v[100:103], a[100:103], v[160:163], v[100:103]
    ds_read_b128 v[132:135], v242 offset:10240
    s_lshl_b32 s7, s7, 7
    v_mfma_f32_16x16x32_bf16 v[104:107], a[104:107], v[160:163], v[104:107]
    ds_read_b128 v[136:139], v243 offset:8192
    s_add_u32 s8, s51, s7
    v_mfma_f32_16x16x32_bf16 v[108:111], a[108:111], v[160:163], v[108:111]
    ds_read_b128 v[140:143], v243 offset:10240
    s_add_u32 m0, s56, 155648
    v_mfma_f32_16x16x32_bf16 v[112:115], a[96:99], v[164:167], v[112:115]
    ds_read_b128 v[144:147], v242 offset:16384
    v_mfma_f32_16x16x32_bf16 v[116:119], a[100:103], v[164:167], v[116:119]
    buffer_load_dwordx4 v224, s[20:23], s8 offen lds
    v_mfma_f32_16x16x32_bf16 v[120:123], a[104:107], v[164:167], v[120:123]
    ds_read_b64_tr_b16 a[192:193], v232 offset:8192
    s_bfe_u32 s7, s75, 0x4001c
    v_mfma_f32_16x16x32_bf16 v[124:127], a[108:111], v[164:167], v[124:127]
    ds_read_b64_tr_b16 a[194:195], v232 offset:8448
    s_lshl_b32 s7, s7, 7
    v_mfma_f32_16x16x32_bf16 v[96:99], a[112:115], v[168:171], v[96:99]
    ds_read_b128 v[148:151], v242 offset:18432
    s_add_u32 s9, s51, s7
    v_mfma_f32_16x16x32_bf16 v[100:103], a[116:119], v[168:171], v[100:103]
    buffer_load_dwordx4 v225, s[20:23], s8 offen offset:1024 lds
    v_mfma_f32_16x16x32_bf16 v[104:107], a[120:123], v[168:171], v[104:107]
    ds_read_b64_tr_b16 a[196:197], v233 offset:8192
    s_add_u32 m0, s56, 98304
    v_mfma_f32_16x16x32_bf16 v[108:111], a[124:127], v[168:171], v[108:111]
    ds_read_b64_tr_b16 a[198:199], v233 offset:8448
    v_mfma_f32_16x16x32_bf16 v[112:115], a[112:115], v[172:175], v[112:115]
    ds_read_b128 v[152:155], v243 offset:16384
    v_mfma_f32_16x16x32_bf16 v[116:119], a[116:119], v[172:175], v[116:119]
    buffer_load_dwordx4 v224, s[20:23], s9 offen lds
    v_mfma_f32_16x16x32_bf16 v[120:123], a[120:123], v[172:175], v[120:123]
    ds_read_b64_tr_b16 a[208:209], v232 offset:12288
    s_bfe_u32 s10, s58, 0x40004
    v_mfma_f32_16x16x32_bf16 v[124:127], a[124:127], v[172:175], v[124:127]
    ds_read_b64_tr_b16 a[210:211], v232 offset:12544
    s_waitcnt lgkmcnt(12)
    v_mfma_f32_16x16x32_bf16 v[0:3], a[128:131], v[128:131], v[0:3]
    ds_read_b128 v[156:159], v243 offset:18432
    s_lshl_b32 s10, s10, 17
    v_mfma_f32_16x16x32_bf16 v[4:7], a[132:135], v[128:131], v[4:7]
    buffer_load_dwordx4 v225, s[20:23], s9 offen offset:1024 lds
    v_mfma_f32_16x16x32_bf16 v[8:11], a[136:139], v[128:131], v[8:11]
    s_add_u32 s10, s10, s69
    s_add_u32 s18, s10, 0
    s_add_u32 m0, s56, 131072
    v_mfma_f32_16x16x32_bf16 v[12:15], a[140:143], v[128:131], v[12:15]
    ds_read_b64_tr_b16 a[212:213], v233 offset:12288
    s_waitcnt vmcnt(12) lgkmcnt(13)
    v_mfma_f32_16x16x32_bf16 v[16:19], a[128:131], v[132:135], v[16:19]
    ds_read_b128 v[160:163], v242 offset:24576
    v_mfma_f32_16x16x32_bf16 v[20:23], a[132:135], v[132:135], v[20:23]
    buffer_load_dwordx4 v234, s[32:35], s18 offen lds
    v_mfma_f32_16x16x32_bf16 v[24:27], a[136:139], v[132:135], v[24:27]
    ds_read_b64_tr_b16 a[214:215], v233 offset:12544
    s_add_u32 s19, s10, 65536
    v_mfma_f32_16x16x32_bf16 v[28:31], a[140:143], v[132:135], v[28:31]
    ds_read_b64_tr_b16 a[200:201], v230 offset:40960
    s_waitcnt lgkmcnt(15)
    v_mfma_f32_16x16x32_bf16 v[0:3], a[144:147], v[136:139], v[0:3]
    ds_read_b128 v[164:167], v242 offset:26624
    v_mfma_f32_16x16x32_bf16 v[4:7], a[148:151], v[136:139], v[4:7]
    buffer_load_dwordx4 v235, s[32:35], s18 offen offset:1024 lds
    v_mfma_f32_16x16x32_bf16 v[8:11], a[152:155], v[136:139], v[8:11]
    ds_read_b64_tr_b16 a[202:203], v230 offset:41216
    s_add_u32 m0, s56, 65536
    v_mfma_f32_16x16x32_bf16 v[12:15], a[156:159], v[136:139], v[12:15]
    ds_read_b64_tr_b16 a[204:205], v231 offset:40960
    s_waitcnt vmcnt(12) lgkmcnt(15)
    v_mfma_f32_16x16x32_bf16 v[16:19], a[144:147], v[140:143], v[16:19]
    ds_read_b128 v[168:171], v243 offset:24576
    v_mfma_f32_16x16x32_bf16 v[20:23], a[148:151], v[140:143], v[20:23]
    buffer_load_dwordx4 v234, s[32:35], s19 offen lds
    v_mfma_f32_16x16x32_bf16 v[24:27], a[152:155], v[140:143], v[24:27]
    ds_read_b64_tr_b16 a[206:207], v231 offset:41216
    s_add_u32 s18, s10, 917504
    v_mfma_f32_16x16x32_bf16 v[28:31], a[156:159], v[140:143], v[28:31]
    ds_read_b64_tr_b16 a[216:217], v230 offset:45056
    v_mfma_f32_16x16x32_bf16 v[0:3], a[160:163], v[144:147], v[0:3]
    ds_read_b128 v[172:175], v243 offset:26624
    v_mfma_f32_16x16x32_bf16 v[4:7], a[164:167], v[144:147], v[4:7]
    buffer_load_dwordx4 v235, s[32:35], s19 offen offset:1024 lds
    v_mfma_f32_16x16x32_bf16 v[8:11], a[168:171], v[144:147], v[8:11]
    ds_read_b64_tr_b16 a[218:219], v230 offset:45312
    s_add_u32 m0, s56, 73728
    v_mfma_f32_16x16x32_bf16 v[12:15], a[172:175], v[144:147], v[12:15]
    ds_read_b64_tr_b16 a[220:221], v231 offset:45056
    s_waitcnt vmcnt(12) lgkmcnt(15)
    v_mfma_f32_16x16x32_bf16 v[16:19], a[160:163], v[148:151], v[16:19]
    ds_read_b128 v[128:131], v244 offset:49152
    v_mfma_f32_16x16x32_bf16 v[20:23], a[164:167], v[148:151], v[20:23]
    buffer_load_dwordx4 v234, s[32:35], s18 offen lds
    v_mfma_f32_16x16x32_bf16 v[24:27], a[168:171], v[148:151], v[24:27]
    ds_read_b64_tr_b16 a[222:223], v231 offset:45312
    s_bfe_u32 s7, s75, 0x40010
    v_mfma_f32_16x16x32_bf16 v[28:31], a[172:175], v[148:151], v[28:31]
    ds_read_b64_tr_b16 a[224:225], v230 offset:57344
    s_lshl_b32 s7, s7, 7
    v_mfma_f32_16x16x32_bf16 v[0:3], a[176:179], v[152:155], v[0:3]
    ds_read_b128 v[132:135], v244 offset:51200
    s_bitcmp1_b32 s98, 13
    s_cselect_b32 s51, s55, s54
    v_mfma_f32_16x16x32_bf16 v[4:7], a[180:183], v[152:155], v[4:7]
    buffer_load_dwordx4 v235, s[32:35], s18 offen offset:1024 lds
    v_mfma_f32_16x16x32_bf16 v[8:11], a[184:187], v[152:155], v[8:11]
    s_add_u32 s8, s51, s7
    s_add_u32 m0, s56, 81920
    v_mfma_f32_16x16x32_bf16 v[12:15], a[188:191], v[152:155], v[12:15]
    ds_read_b64_tr_b16 a[226:227], v230 offset:57600
    s_waitcnt lgkmcnt(15)
    v_mfma_f32_16x16x32_bf16 v[16:19], a[176:179], v[156:159], v[16:19]
    ds_read_b128 v[136:139], v245 offset:49152
    v_mfma_f32_16x16x32_bf16 v[20:23], a[180:183], v[156:159], v[20:23]
    buffer_load_dwordx4 v224, s[20:23], s8 offen lds
    v_mfma_f32_16x16x32_bf16 v[24:27], a[184:187], v[156:159], v[24:27]
    ds_read_b64_tr_b16 a[228:229], v231 offset:57344
    s_bfe_u32 s7, s75, 0x40014
    v_mfma_f32_16x16x32_bf16 v[28:31], a[188:191], v[156:159], v[28:31]
    ds_read_b64_tr_b16 a[230:231], v231 offset:57600
    s_waitcnt lgkmcnt(12)
    v_mfma_f32_16x16x32_bf16 v[0:3], a[192:195], v[160:163], v[0:3]
    ds_read_b128 v[140:143], v245 offset:51200
    s_lshl_b32 s7, s7, 7
    v_mfma_f32_16x16x32_bf16 v[4:7], a[196:199], v[160:163], v[4:7]
    buffer_load_dwordx4 v225, s[20:23], s8 offen offset:1024 lds
    v_mfma_f32_16x16x32_bf16 v[8:11], a[200:203], v[160:163], v[8:11]
    s_add_u32 s9, s51, s7
    s_add_u32 m0, s56, 90112
    v_mfma_f32_16x16x32_bf16 v[12:15], a[204:207], v[160:163], v[12:15]
    ds_read_b64_tr_b16 a[240:241], v230 offset:61440
    v_mfma_f32_16x16x32_bf16 v[16:19], a[192:195], v[164:167], v[16:19]
    buffer_load_dwordx4 v224, s[20:23], s9 offen lds
    v_mfma_f32_16x16x32_bf16 v[20:23], a[196:199], v[164:167], v[20:23]
    ds_read_b64_tr_b16 a[242:243], v230 offset:61696
    v_mfma_f32_16x16x32_bf16 v[24:27], a[200:203], v[164:167], v[24:27]
    ds_read_b64_tr_b16 a[244:245], v231 offset:61440
    v_mfma_f32_16x16x32_bf16 v[28:31], a[204:207], v[164:167], v[28:31]
    ds_read_b64_tr_b16 a[246:247], v231 offset:61696
    s_waitcnt lgkmcnt(11)
    v_mfma_f32_16x16x32_bf16 v[0:3], a[208:211], v[168:171], v[0:3]
    buffer_load_dwordx4 v225, s[20:23], s9 offen offset:1024 lds
    v_mfma_f32_16x16x32_bf16 v[4:7], a[212:215], v[168:171], v[4:7]
    ds_read_b64_tr_b16 a[232:233], v228 offset:0
    v_mfma_f32_16x16x32_bf16 v[8:11], a[216:219], v[168:171], v[8:11]
    ds_read_b64_tr_b16 a[234:235], v228 offset:256
    v_mfma_f32_16x16x32_bf16 v[12:15], a[220:223], v[168:171], v[12:15]
    ds_read_b64_tr_b16 a[236:237], v229 offset:0
    v_mfma_f32_16x16x32_bf16 v[16:19], a[208:211], v[172:175], v[16:19]
    ds_read_b64_tr_b16 a[238:239], v229 offset:256
    v_mfma_f32_16x16x32_bf16 v[20:23], a[212:215], v[172:175], v[20:23]
    ds_read_b64_tr_b16 a[248:249], v228 offset:4096
    v_mfma_f32_16x16x32_bf16 v[24:27], a[216:219], v[172:175], v[24:27]
    ds_read_b64_tr_b16 a[250:251], v228 offset:4352
    v_mfma_f32_16x16x32_bf16 v[28:31], a[220:223], v[172:175], v[28:31]
    ds_read_b64_tr_b16 a[252:253], v229 offset:4096
    s_waitcnt lgkmcnt(3)
    v_mfma_f32_16x16x32_bf16 v[0:3], a[224:227], v[128:131], v[0:3]
    s_waitcnt vmcnt(10)
    s_barrier
    ds_read_b128 v[144:147], v242 offset:49152
    s_bfe_u32 s7, s75, 0x40018
    v_mfma_f32_16x16x32_bf16 v[4:7], a[228:231], v[128:131], v[4:7]
    ds_read_b128 v[148:151], v242 offset:51200
    s_lshl_b32 s7, s7, 7
    v_mfma_f32_16x16x32_bf16 v[8:11], a[232:235], v[128:131], v[8:11]
    ds_read_b128 v[152:155], v243 offset:49152
    s_add_u32 s8, s51, s7
    v_mfma_f32_16x16x32_bf16 v[12:15], a[236:239], v[128:131], v[12:15]
    ds_read_b128 v[156:159], v243 offset:51200
    s_add_u32 m0, s56, 8192
    v_mfma_f32_16x16x32_bf16 v[16:19], a[224:227], v[132:135], v[16:19]
    ds_read_b128 v[160:163], v242 offset:57344
    v_mfma_f32_16x16x32_bf16 v[20:23], a[228:231], v[132:135], v[20:23]
    buffer_load_dwordx4 v224, s[20:23], s8 offen lds
    v_mfma_f32_16x16x32_bf16 v[24:27], a[232:235], v[132:135], v[24:27]
    ds_read_b64_tr_b16 a[254:255], v229 offset:4352
    s_bfe_u32 s7, s75, 0x4001c
    v_mfma_f32_16x16x32_bf16 v[28:31], a[236:239], v[132:135], v[28:31]
    ds_read_b64_tr_b16 v[184:185], v240 offset:16384
    s_waitcnt lgkmcnt(1)
    v_mfma_f32_16x16x32_bf16 v[0:3], a[240:243], v[136:139], v[0:3]
    ds_read_b128 v[164:167], v242 offset:59392
L_ST3:
    s_cbranch_execz L_ST7
L_D1_16:
    s_cbranch_execz L_DW1
    s_lshl_b32 s7, s7, 7
    v_mfma_f32_16x16x32_bf16 v[4:7], a[244:247], v[136:139], v[4:7]
    buffer_load_dwordx4 v225, s[20:23], s8 offen offset:1024 lds
    v_mfma_f32_16x16x32_bf16 v[8:11], a[248:251], v[136:139], v[8:11]
    s_add_u32 s9, s51, s7
    s_add_u32 m0, s56, 139264
    v_mfma_f32_16x16x32_bf16 v[12:15], a[252:255], v[136:139], v[12:15]
    ds_read_b64_tr_b16 v[186:187], v240 offset:17408
    v_mfma_f32_16x16x32_bf16 v[16:19], a[240:243], v[140:143], v[16:19]
    ds_read_b128 v[168:171], v243 offset:57344
    v_mfma_f32_16x16x32_bf16 v[20:23], a[244:247], v[140:143], v[20:23]
    buffer_load_dwordx4 v224, s[20:23], s9 offen lds
    v_mfma_f32_16x16x32_bf16 v[24:27], a[248:251], v[140:143], v[24:27]
    ds_read_b64_tr_b16 v[188:189], v241 offset:16384
    s_add_u32 s19, s10, 983040
    v_mfma_f32_16x16x32_bf16 v[28:31], a[252:255], v[140:143], v[28:31]
    ds_read_b64_tr_b16 v[190:191], v241 offset:17408
    s_waitcnt vmcnt(11)
    v_pk_mul_f32 v[8:9], v[0:1], v[8:9]
    v_pk_mul_f32 v[10:11], v[2:3], v[10:11]
    v_pk_mul_f32 v[12:13], v[4:5], v[12:13]
    v_pk_mul_f32 v[14:15], v[6:7], v[14:15]
    v_pk_mul_f32 v[0:1], v[0:1], s[76:77]
    v_pk_mul_f32 v[2:3], v[2:3], s[76:77]
    v_pk_mul_f32 v[4:5], v[4:5], s[76:77]
    v_pk_mul_f32 v[6:7], v[6:7], s[76:77]
    ds_read_b64_tr_b16 v[192:193], v236 offset:32768
    buffer_load_dwordx4 v225, s[20:23], s9 offen offset:1024 lds
    v_exp_f32 v0, v0
    v_exp_f32 v1, v1
    v_exp_f32 v2, v2
    v_exp_f32 v3, v3
    v_exp_f32 v4, v4
    v_exp_f32 v5, v5
    v_exp_f32 v6, v6
    v_exp_f32 v7, v7
    ds_read_b64_tr_b16 v[194:195], v236 offset:33792
    s_add_u32 m0, s56, 106496
    s_nop 0
    buffer_load_dwordx4 v234, s[32:35], s19 offen lds
    v_pk_add_f32 v[0:1], v[0:1], s[78:79]
    v_pk_add_f32 v[2:3], v[2:3], s[78:79]
    v_pk_add_f32 v[4:5], v[4:5], s[78:79]
    v_pk_add_f32 v[6:7], v[6:7], s[78:79]
    v_rcp_f32 v0, v0
    v_rcp_f32 v1, v1
    v_rcp_f32 v2, v2
    v_rcp_f32 v3, v3
    ds_read_b64_tr_b16 v[196:197], v237 offset:32768
    buffer_load_dwordx4 v235, s[32:35], s19 offen offset:1024 lds
    v_rcp_f32 v4, v4
    v_rcp_f32 v5, v5
    v_rcp_f32 v6, v6
    v_rcp_f32 v7, v7
    s_add_u32 s61, s70, 0
    v_pk_mul_f32 v[8:9], v[8:9], v[0:1]
    v_pk_mul_f32 v[10:11], v[10:11], v[2:3]
    v_pk_mul_f32 v[12:13], v[12:13], v[4:5]
    v_pk_mul_f32 v[14:15], v[14:15], v[6:7]
    ds_read_b64_tr_b16 v[198:199], v237 offset:33792
    s_add_u32 m0, s56, 16384
    s_bfe_u32 s10, s58, 0x40008
    s_lshl_b32 s10, s10, 17
    s_add_u32 s10, s10, s69
    s_add_u32 s18, s10, 0
    buffer_load_dwordx4 v234, s[32:35], s18 offen lds
    v_cvt_pk_bf16_f32 v0, v8, v9
    v_cvt_pk_bf16_f32 v1, v10, v11
    v_cvt_pk_bf16_f32 v2, v12, v13
    v_cvt_pk_bf16_f32 v3, v14, v15
    buffer_store_dwordx4 v[0:3], v252, s[44:47], s61 offen sc1
    v_pk_mul_f32 v[24:25], v[16:17], v[24:25]
    v_pk_mul_f32 v[26:27], v[18:19], v[26:27]
    v_pk_mul_f32 v[28:29], v[20:21], v[28:29]
    v_pk_mul_f32 v[30:31], v[22:23], v[30:31]
    v_pk_mul_f32 v[16:17], v[16:17], s[76:77]
    v_pk_mul_f32 v[18:19], v[18:19], s[76:77]
    v_pk_mul_f32 v[20:21], v[20:21], s[76:77]
    v_pk_mul_f32 v[22:23], v[22:23], s[76:77]
    ds_read_b64_tr_b16 v[200:201], v236 offset:40960
    buffer_load_dwordx4 v235, s[32:35], s18 offen offset:1024 lds
    v_exp_f32 v16, v16
    v_exp_f32 v17, v17
    v_exp_f32 v18, v18
    v_exp_f32 v19, v19
    v_exp_f32 v20, v20
    v_exp_f32 v21, v21
    v_exp_f32 v22, v22
    v_exp_f32 v23, v23
    ds_read_b64_tr_b16 v[202:203], v236 offset:41984
    s_add_u32 m0, s56, 24576
    s_add_u32 s19, s10, 65536
    buffer_load_dwordx4 v234, s[32:35], s19 offen lds
    v_pk_add_f32 v[16:17], v[16:17], s[78:79]
    v_pk_add_f32 v[18:19], v[18:19], s[78:79]
    v_pk_add_f32 v[20:21], v[20:21], s[78:79]
    v_pk_add_f32 v[22:23], v[22:23], s[78:79]
    v_rcp_f32 v16, v16
    v_rcp_f32 v17, v17
    v_rcp_f32 v18, v18
    v_rcp_f32 v19, v19
    ds_read_b64_tr_b16 v[204:205], v237 offset:40960
    v_rcp_f32 v20, v20
    v_rcp_f32 v21, v21
    v_rcp_f32 v22, v22
    v_rcp_f32 v23, v23
    s_add_u32 s61, s70, 16384
    v_pk_mul_f32 v[24:25], v[24:25], v[16:17]
    v_pk_mul_f32 v[26:27], v[26:27], v[18:19]
    v_pk_mul_f32 v[28:29], v[28:29], v[20:21]
    v_pk_mul_f32 v[30:31], v[30:31], v[22:23]
    v_cvt_pk_bf16_f32 v16, v24, v25
    v_cvt_pk_bf16_f32 v17, v26, v27
    v_cvt_pk_bf16_f32 v18, v28, v29
    ds_read_b64_tr_b16 v[206:207], v237 offset:41984
    buffer_load_dwordx4 v235, s[32:35], s19 offen offset:1024 lds
    v_cvt_pk_bf16_f32 v19, v30, v31
    buffer_store_dwordx4 v[16:19], v252, s[44:47], s61 offen sc1
    s_waitcnt lgkmcnt(0)
    s_cmp_eq_u32 s97, 0
    s_cbranch_scc1 L_NRETRY
L_NOK:
    v_mov_b32 v248, s96
    v_mov_b32 v249, s97
    v_mfma_f32_16x16x32_bf16 v[32:35], a[128:131], v[144:147], v[32:35]
    ds_read_b128 v[172:175], v243 offset:59392
    s_add_u32 s18, s10, 917504
    v_mfma_f32_16x16x32_bf16 v[36:39], a[132:135], v[144:147], v[36:39]
    ds_read_b64_tr_b16 v[208:209], v240 offset:0
    s_add_u32 m0, s56, 114688
    v_mfma_f32_16x16x32_bf16 v[40:43], a[136:139], v[144:147], v[40:43]
    ds_read_b64_tr_b16 v[210:211], v240 offset:1024
    v_mfma_f32_16x16x32_bf16 v[44:47], a[140:143], v[144:147], v[44:47]
    ds_read_b64_tr_b16 v[212:213], v241 offset:0
    s_waitcnt vmcnt(16)
    v_mfma_f32_16x16x32_bf16 v[48:51], a[128:131], v[148:151], v[48:51]
    ds_read_b128 v[128:131], v246 offset:24576
    v_mfma_f32_16x16x32_bf16 v[52:55], a[132:135], v[148:151], v[52:55]
    buffer_load_dwordx4 v234, s[32:35], s18 offen lds
    v_mfma_f32_16x16x32_bf16 v[56:59], a[136:139], v[148:151], v[56:59]
    ds_read_b64_tr_b16 v[214:215], v241 offset:1024
    s_add_u32 s19, s10, 983040
    v_mfma_f32_16x16x32_bf16 v[60:63], a[140:143], v[148:151], v[60:63]
    ds_read_b64_tr_b16 v[216:217], v238 offset:0
    v_mfma_f32_16x16x32_bf16 v[32:35], a[144:147], v[152:155], v[32:35]
    ds_read_b128 v[132:135], v246 offset:26624
    v_mfma_f32_16x16x32_bf16 v[36:39], a[148:151], v[152:155], v[36:39]
    buffer_load_dwordx4 v235, s[32:35], s18 offen offset:1024 lds
    v_mfma_f32_16x16x32_bf16 v[40:43], a[152:155], v[152:155], v[40:43]
    ds_read_b64_tr_b16 v[218:219], v238 offset:1024
    s_add_u32 m0, s56, 147456
    v_mfma_f32_16x16x32_bf16 v[44:47], a[156:159], v[152:155], v[44:47]
    ds_read_b64_tr_b16 v[220:221], v239 offset:0
    v_mfma_f32_16x16x32_bf16 v[48:51], a[144:147], v[156:159], v[48:51]
    ds_read_b128 v[136:139], v247 offset:24576
    v_mfma_f32_16x16x32_bf16 v[52:55], a[148:151], v[156:159], v[52:55]
    buffer_load_dwordx4 v234, s[32:35], s19 offen lds
    v_mfma_f32_16x16x32_bf16 v[56:59], a[152:155], v[156:159], v[56:59]
    ds_read_b64_tr_b16 v[222:223], v239 offset:1024
    s_bfe_u32 s10, s58, 0x4000c
    v_mfma_f32_16x16x32_bf16 v[60:63], a[156:159], v[156:159], v[60:63]
    ds_read_b64_tr_b16 a[0:1], v238 offset:8192
    s_waitcnt lgkmcnt(7)
    v_mfma_f32_16x16x32_bf16 v[32:35], a[160:163], v[160:163], v[32:35]
    ds_read_b128 v[140:143], v247 offset:26624
    s_lshl_b32 s10, s10, 17
    v_mfma_f32_16x16x32_bf16 v[36:39], a[164:167], v[160:163], v[36:39]
    buffer_load_dwordx4 v235, s[32:35], s19 offen offset:1024 lds
    v_mfma_f32_16x16x32_bf16 v[40:43], a[168:171], v[160:163], v[40:43]
    s_add_u32 s10, s10, s69
    s_add_u32 s18, s10, 0
    s_add_u32 m0, s56, 122880
    v_mfma_f32_16x16x32_bf16 v[44:47], a[172:175], v[160:163], v[44:47]
    ds_read_b64_tr_b16 a[2:3], v238 offset:9216
    v_mfma_f32_16x16x32_bf16 v[48:51], a[160:163], v[164:167], v[48:51]
    ds_read_b128 v[144:147], v244 offset:32768
    v_mfma_f32_16x16x32_bf16 v[52:55], a[164:167], v[164:167], v[52:55]
    buffer_load_dwordx4 v234, s[32:35], s18 offen lds
    v_mfma_f32_16x16x32_bf16 v[56:59], a[168:171], v[164:167], v[56:59]
    ds_read_b64_tr_b16 a[4:5], v239 offset:8192
    s_bfe_u32 s7, s75, 0x40010
    v_mfma_f32_16x16x32_bf16 v[60:63], a[172:175], v[164:167], v[60:63]
    ds_read_b64_tr_b16 a[6:7], v239 offset:9216
    s_waitcnt lgkmcnt(6)
    v_mfma_f32_16x16x32_bf16 v[32:35], a[176:179], v[168:171], v[32:35]
    ds_read_b128 v[148:151], v244 offset:34816
    s_lshl_b32 s7, s7, 7
    v_mfma_f32_16x16x32_bf16 v[36:39], a[180:183], v[168:171], v[36:39]
    buffer_load_dwordx4 v235, s[32:35], s18 offen offset:1024 lds
    v_mfma_f32_16x16x32_bf16 v[40:43], a[184:187], v[168:171], v[40:43]
    s_bitcmp1_b32 s98, 13
    s_cselect_b32 s51, s54, s55
    s_add_u32 s8, s51, s7
    s_add_u32 m0, s56, 131072
    v_mfma_f32_16x16x32_bf16 v[44:47], a[188:191], v[168:171], v[44:47]
    v_mfma_f32_16x16x32_bf16 v[48:51], a[176:179], v[172:175], v[48:51]
    ds_read_b128 v[152:155], v245 offset:32768
    v_mfma_f32_16x16x32_bf16 v[52:55], a[180:183], v[172:175], v[52:55]
    v_mfma_f32_16x16x32_bf16 v[56:59], a[184:187], v[172:175], v[56:59]
    buffer_load_dwordx4 v224, s[20:23], s8 offen lds
    v_mfma_f32_16x16x32_bf16 v[60:63], a[188:191], v[172:175], v[60:63]
    s_bfe_u32 s7, s75, 0x40014
    s_lshl_b32 s7, s7, 7
    s_add_u32 s9, s51, s7
    v_mfma_f32_16x16x32_bf16 v[32:35], a[192:195], v[128:131], v[32:35]
    ds_read_b128 v[156:159], v245 offset:34816
    v_mfma_f32_16x16x32_bf16 v[36:39], a[196:199], v[128:131], v[36:39]
    v_mfma_f32_16x16x32_bf16 v[40:43], a[200:203], v[128:131], v[40:43]
    buffer_load_dwordx4 v225, s[20:23], s8 offen offset:1024 lds
    v_mfma_f32_16x16x32_bf16 v[44:47], a[204:207], v[128:131], v[44:47]
    s_add_u32 m0, s56, 65536
    s_waitcnt vmcnt(14) lgkmcnt(3)
    v_mfma_f32_16x16x32_bf16 v[48:51], a[192:195], v[132:135], v[48:51]
    ds_read_b64_tr_b16 a[8:9], v238 offset:40960
    v_mfma_f32_16x16x32_bf16 v[52:55], a[196:199], v[132:135], v[52:55]
    ds_read_b64_tr_b16 a[10:11], v238 offset:41984
    v_mfma_f32_16x16x32_bf16 v[56:59], a[200:203], v[132:135], v[56:59]
    buffer_load_dwordx4 v224, s[20:23], s9 offen lds
    v_mfma_f32_16x16x32_bf16 v[60:63], a[204:207], v[132:135], v[60:63]
    ds_read_b64_tr_b16 a[12:13], v239 offset:40960
    s_bfe_u32 s7, s75, 0x40018
    v_mfma_f32_16x16x32_bf16 v[32:35], a[208:211], v[136:139], v[32:35]
    ds_read_b64_tr_b16 a[14:15], v239 offset:41984
    s_lshl_b32 s7, s7, 7
    v_mfma_f32_16x16x32_bf16 v[36:39], a[212:215], v[136:139], v[36:39]
    s_add_u32 s8, s51, s7
    v_mfma_f32_16x16x32_bf16 v[40:43], a[216:219], v[136:139], v[40:43]
    v_mfma_f32_16x16x32_bf16 v[44:47], a[220:223], v[136:139], v[44:47]
    buffer_load_dwordx4 v225, s[20:23], s9 offen offset:1024 lds
    v_mfma_f32_16x16x32_bf16 v[48:51], a[208:211], v[140:143], v[48:51]
    s_add_u32 m0, s56, 73728
    v_mfma_f32_16x16x32_bf16 v[52:55], a[212:215], v[140:143], v[52:55]
    v_mfma_f32_16x16x32_bf16 v[56:59], a[216:219], v[140:143], v[56:59]
    v_mfma_f32_16x16x32_bf16 v[60:63], a[220:223], v[140:143], v[60:63]
    buffer_load_dwordx4 v224, s[20:23], s8 offen lds
    v_mfma_f32_16x16x32_bf16 v[32:35], a[224:227], v[144:147], v[32:35]
    s_waitcnt lgkmcnt(4)
    s_barrier
    ds_read_b128 v[160:163], v244 offset:16384
    s_bfe_u32 s7, s75, 0x4001c
    v_mfma_f32_16x16x32_bf16 v[36:39], a[228:231], v[144:147], v[36:39]
    ds_read_b128 v[164:167], v244 offset:18432
    s_lshl_b32 s7, s7, 7
    v_mfma_f32_16x16x32_bf16 v[40:43], a[232:235], v[144:147], v[40:43]
    ds_read_b128 v[168:171], v245 offset:16384
    s_add_u32 s9, s51, s7
    v_mfma_f32_16x16x32_bf16 v[44:47], a[236:239], v[144:147], v[44:47]
    ds_read_b128 v[172:175], v245 offset:18432
    s_waitcnt lgkmcnt(4)
    v_mfma_f32_16x16x32_bf16 v[48:51], a[224:227], v[148:151], v[48:51]
    ds_read_b128 v[128:131], v244 offset:24576
    v_mfma_f32_16x16x32_bf16 v[52:55], a[228:231], v[148:151], v[52:55]
    buffer_load_dwordx4 v225, s[20:23], s8 offen offset:1024 lds
    v_mfma_f32_16x16x32_bf16 v[56:59], a[232:235], v[148:151], v[56:59]
    s_add_u32 m0, s56, 0
    v_mfma_f32_16x16x32_bf16 v[60:63], a[236:239], v[148:151], v[60:63]
    s_waitcnt vmcnt(12)
    s_mov_b64 exec, 1
    buffer_store_dwordx2 v[248:249], off, s[44:47], s71 offset:0 sc1
    s_mov_b64 exec, -1
    v_mfma_f32_16x16x32_bf16 v[32:35], a[240:243], v[152:155], v[32:35]
    ds_read_b128 v[132:135], v244 offset:26624
    v_mfma_f32_16x16x32_bf16 v[36:39], a[244:247], v[152:155], v[36:39]
    buffer_load_dwordx4 v224, s[20:23], s9 offen lds
    v_mfma_f32_16x16x32_bf16 v[40:43], a[248:251], v[152:155], v[40:43]
    ds_read_b64_tr_b16 a[16:17], v236 offset:16384
    s_add_u32 s19, s10, 65536
    v_mfma_f32_16x16x32_bf16 v[44:47], a[252:255], v[152:155], v[44:47]
    ds_read_b64_tr_b16 a[18:19], v236 offset:17408
    v_mfma_f32_16x16x32_bf16 v[48:51], a[240:243], v[156:159], v[48:51]
    ds_read_b128 v[136:139], v245 offset:24576
    v_mfma_f32_16x16x32_bf16 v[52:55], a[244:247], v[156:159], v[52:55]
    buffer_load_dwordx4 v225, s[20:23], s9 offen offset:1024 lds
    v_mfma_f32_16x16x32_bf16 v[56:59], a[248:251], v[156:159], v[56:59]
    ds_read_b64_tr_b16 a[20:21], v237 offset:16384
    s_add_u32 m0, s56, 155648
    v_mfma_f32_16x16x32_bf16 v[60:63], a[252:255], v[156:159], v[60:63]
    ds_read_b64_tr_b16 a[22:23], v237 offset:17408
    s_waitcnt vmcnt(9) lgkmcnt(10)
    v_add_u32 v228, 65536, v252
    v_add_u32 v229, 131072, v252
    v_pk_mul_f32 v[40:41], v[32:33], v[40:41]
    v_pk_mul_f32 v[42:43], v[34:35], v[42:43]
    v_pk_mul_f32 v[44:45], v[36:37], v[44:45]
    v_pk_mul_f32 v[46:47], v[38:39], v[46:47]
    v_pk_mul_f32 v[32:33], v[32:33], s[76:77]
    v_pk_mul_f32 v[34:35], v[34:35], s[76:77]
    v_pk_mul_f32 v[36:37], v[36:37], s[76:77]
    v_pk_mul_f32 v[38:39], v[38:39], s[76:77]
    ds_read_b64_tr_b16 a[24:25], v236 offset:24576
    buffer_load_dwordx4 v234, s[32:35], s19 offen lds
    v_exp_f32 v32, v32
    v_exp_f32 v33, v33
    v_exp_f32 v34, v34
    v_exp_f32 v35, v35
    v_exp_f32 v36, v36
    v_exp_f32 v37, v37
    v_exp_f32 v38, v38
    v_exp_f32 v39, v39
    ds_read_b64_tr_b16 a[26:27], v236 offset:25600
    buffer_load_dwordx4 v235, s[32:35], s19 offen offset:1024 lds
    v_pk_add_f32 v[32:33], v[32:33], s[78:79]
    v_pk_add_f32 v[34:35], v[34:35], s[78:79]
    v_pk_add_f32 v[36:37], v[36:37], s[78:79]
    v_pk_add_f32 v[38:39], v[38:39], s[78:79]
    v_rcp_f32 v32, v32
    v_rcp_f32 v33, v33
    v_rcp_f32 v34, v34
    v_rcp_f32 v35, v35
    ds_read_b64_tr_b16 a[28:29], v237 offset:24576
    s_add_u32 m0, s56, 106496
    s_add_u32 s18, s10, 917504
    buffer_load_dwordx4 v234, s[32:35], s18 offen lds
    v_rcp_f32 v36, v36
    v_rcp_f32 v37, v37
    v_rcp_f32 v38, v38
    v_rcp_f32 v39, v39
    s_add_u32 s61, s70, 262144
    v_pk_mul_f32 v[40:41], v[40:41], v[32:33]
    v_pk_mul_f32 v[42:43], v[42:43], v[34:35]
    v_pk_mul_f32 v[44:45], v[44:45], v[36:37]
    v_pk_mul_f32 v[46:47], v[46:47], v[38:39]
    ds_read_b64_tr_b16 a[30:31], v237 offset:25600
    buffer_load_dwordx4 v235, s[32:35], s18 offen offset:1024 lds
    v_cvt_pk_bf16_f32 v32, v40, v41
    v_cvt_pk_bf16_f32 v33, v42, v43
    v_cvt_pk_bf16_f32 v34, v44, v45
    v_cvt_pk_bf16_f32 v35, v46, v47
    buffer_store_dwordx4 v[32:35], v252, s[44:47], s61 offen sc1
    v_pk_mul_f32 v[56:57], v[48:49], v[56:57]
    v_pk_mul_f32 v[58:59], v[50:51], v[58:59]
    v_pk_mul_f32 v[60:61], v[52:53], v[60:61]
    v_pk_mul_f32 v[62:63], v[54:55], v[62:63]
    v_pk_mul_f32 v[48:49], v[48:49], s[76:77]
    v_pk_mul_f32 v[50:51], v[50:51], s[76:77]
    v_pk_mul_f32 v[52:53], v[52:53], s[76:77]
    v_pk_mul_f32 v[54:55], v[54:55], s[76:77]
    ds_read_b64_tr_b16 a[32:33], v238 offset:49152
    s_add_u32 m0, s56, 98304
    s_add_u32 s19, s10, 983040
    buffer_load_dwordx4 v234, s[32:35], s19 offen lds
    v_exp_f32 v48, v48
    v_exp_f32 v49, v49
    v_exp_f32 v50, v50
    v_exp_f32 v51, v51
    v_exp_f32 v52, v52
    v_exp_f32 v53, v53
    v_exp_f32 v54, v54
    v_exp_f32 v55, v55
    ds_read_b64_tr_b16 a[34:35], v238 offset:50176
    buffer_load_dwordx4 v235, s[32:35], s19 offen offset:1024 lds
    v_pk_add_f32 v[48:49], v[48:49], s[78:79]
    v_pk_add_f32 v[50:51], v[50:51], s[78:79]
    v_pk_add_f32 v[52:53], v[52:53], s[78:79]
    v_pk_add_f32 v[54:55], v[54:55], s[78:79]
    v_rcp_f32 v48, v48
    v_rcp_f32 v49, v49
    v_rcp_f32 v50, v50
    v_rcp_f32 v51, v51
    ds_read_b64_tr_b16 a[36:37], v239 offset:49152
    s_add_u32 m0, s56, 40960
    s_bfe_u32 s10, s58, 0x40010
    s_lshl_b32 s10, s10, 17
    s_add_u32 s10, s10, s69
    s_add_u32 s18, s10, 0
    buffer_load_dwordx4 v234, s[32:35], s18 offen lds
    v_rcp_f32 v52, v52
    v_rcp_f32 v53, v53
    v_rcp_f32 v54, v54
    v_rcp_f32 v55, v55
    s_add_u32 s61, s70, 278528
    v_pk_mul_f32 v[56:57], v[56:57], v[48:49]
    v_pk_mul_f32 v[58:59], v[58:59], v[50:51]
    v_pk_mul_f32 v[60:61], v[60:61], v[52:53]
    v_pk_mul_f32 v[62:63], v[62:63], v[54:55]
    v_cvt_pk_bf16_f32 v48, v56, v57
    v_cvt_pk_bf16_f32 v49, v58, v59
    v_cvt_pk_bf16_f32 v50, v60, v61
    ds_read_b64_tr_b16 a[38:39], v239 offset:50176
    buffer_load_dwordx4 v235, s[32:35], s18 offen offset:1024 lds
    v_cvt_pk_bf16_f32 v51, v62, v63
    buffer_store_dwordx4 v[48:51], v252, s[44:47], s61 offen sc1
    v_mfma_f32_16x16x32_bf16 v[64:67], a[128:131], v[160:163], v[64:67]
    ds_read_b128 v[140:143], v245 offset:26624
    s_add_u32 s19, s10, 65536
    v_mfma_f32_16x16x32_bf16 v[68:71], a[132:135], v[160:163], v[68:71]
    ds_read_b64_tr_b16 a[40:41], v240 offset:16384
    s_add_u32 m0, s56, 32768
    v_mfma_f32_16x16x32_bf16 v[72:75], a[136:139], v[160:163], v[72:75]
    ds_read_b64_tr_b16 a[42:43], v240 offset:17408
    v_mfma_f32_16x16x32_bf16 v[76:79], a[140:143], v[160:163], v[76:79]
    ds_read_b64_tr_b16 a[44:45], v241 offset:16384
    s_waitcnt lgkmcnt(15)
    v_mfma_f32_16x16x32_bf16 v[80:83], a[128:131], v[164:167], v[80:83]
    ds_read_b128 v[144:147], v242 offset:8192
    v_mfma_f32_16x16x32_bf16 v[84:87], a[132:135], v[164:167], v[84:87]
    buffer_load_dwordx4 v234, s[32:35], s19 offen lds
    v_mfma_f32_16x16x32_bf16 v[88:91], a[136:139], v[164:167], v[88:91]
    ds_read_b64_tr_b16 a[46:47], v241 offset:17408
    s_add_u32 s18, s10, 917504
    v_mfma_f32_16x16x32_bf16 v[92:95], a[140:143], v[164:167], v[92:95]
    ds_read_b64_tr_b16 a[48:49], v238 offset:57344
    v_mfma_f32_16x16x32_bf16 v[64:67], a[144:147], v[168:171], v[64:67]
    ds_read_b128 v[148:151], v242 offset:10240
    v_mfma_f32_16x16x32_bf16 v[68:71], a[148:151], v[168:171], v[68:71]
    buffer_load_dwordx4 v235, s[32:35], s19 offen offset:1024 lds
    v_mfma_f32_16x16x32_bf16 v[72:75], a[152:155], v[168:171], v[72:75]
    ds_read_b64_tr_b16 a[50:51], v238 offset:58368
    s_add_u32 m0, s56, 49152
    v_mfma_f32_16x16x32_bf16 v[76:79], a[156:159], v[168:171], v[76:79]
    ds_read_b64_tr_b16 a[52:53], v239 offset:57344
    s_waitcnt lgkmcnt(10)
    v_mfma_f32_16x16x32_bf16 v[80:83], a[144:147], v[172:175], v[80:83]
    ds_read_b128 v[152:155], v243 offset:8192
    v_mfma_f32_16x16x32_bf16 v[84:87], a[148:151], v[172:175], v[84:87]
    buffer_load_dwordx4 v234, s[32:35], s18 offen lds
    v_mfma_f32_16x16x32_bf16 v[88:91], a[152:155], v[172:175], v[88:91]
    ds_read_b64_tr_b16 a[54:55], v239 offset:58368
    s_add_u32 s19, s10, 983040
    v_mfma_f32_16x16x32_bf16 v[92:95], a[156:159], v[172:175], v[92:95]
    s_waitcnt lgkmcnt(6)
    v_mfma_f32_16x16x32_bf16 v[64:67], a[160:163], v[128:131], v[64:67]
    ds_read_b128 v[156:159], v243 offset:10240
    v_mfma_f32_16x16x32_bf16 v[68:71], a[164:167], v[128:131], v[68:71]
    buffer_load_dwordx4 v235, s[32:35], s18 offen offset:1024 lds
    v_mfma_f32_16x16x32_bf16 v[72:75], a[168:171], v[128:131], v[72:75]
    s_add_u32 m0, s56, 114688
    v_mfma_f32_16x16x32_bf16 v[76:79], a[172:175], v[128:131], v[76:79]
    v_mfma_f32_16x16x32_bf16 v[80:83], a[160:163], v[132:135], v[80:83]
    ds_read_b128 v[160:163], v246 offset:8192
    v_mfma_f32_16x16x32_bf16 v[84:87], a[164:167], v[132:135], v[84:87]
    buffer_load_dwordx4 v234, s[32:35], s19 offen lds
    v_mfma_f32_16x16x32_bf16 v[88:91], a[168:171], v[132:135], v[88:91]
    s_bfe_u32 s10, s58, 0x40014
    s_lshl_b32 s10, s10, 17
    s_add_u32 s10, s10, s69
    v_mfma_f32_16x16x32_bf16 v[92:95], a[172:175], v[132:135], v[92:95]
    s_add_u32 s18, s10, 0
    s_waitcnt lgkmcnt(2)
    v_mfma_f32_16x16x32_bf16 v[64:67], a[176:179], v[136:139], v[64:67]
    ds_read_b128 v[164:167], v246 offset:10240
    v_mfma_f32_16x16x32_bf16 v[68:71], a[180:183], v[136:139], v[68:71]
    buffer_load_dwordx4 v235, s[32:35], s19 offen offset:1024 lds
    v_mfma_f32_16x16x32_bf16 v[72:75], a[184:187], v[136:139], v[72:75]
    s_add_u32 m0, s56, 147456
    v_mfma_f32_16x16x32_bf16 v[76:79], a[188:191], v[136:139], v[76:79]
    v_mfma_f32_16x16x32_bf16 v[80:83], a[176:179], v[140:143], v[80:83]
    ds_read_b128 v[168:171], v247 offset:8192
    v_mfma_f32_16x16x32_bf16 v[84:87], a[180:183], v[140:143], v[84:87]
    buffer_load_dwordx2 v[250:251], v253, s[44:47], s72 offen offset:0 sc1
    v_mfma_f32_16x16x32_bf16 v[88:91], a[184:187], v[140:143], v[88:91]
    v_mfma_f32_16x16x32_bf16 v[92:95], a[188:191], v[140:143], v[92:95]
    v_mfma_f32_16x16x32_bf16 v[64:67], a[192:195], v[144:147], v[64:67]
    ds_read_b128 v[172:175], v247 offset:10240
    v_mfma_f32_16x16x32_bf16 v[68:71], a[196:199], v[144:147], v[68:71]
    buffer_load_dwordx4 v234, s[32:35], s18 offen lds
    v_mfma_f32_16x16x32_bf16 v[72:75], a[200:203], v[144:147], v[72:75]
    s_add_u32 s19, s10, 65536
    v_mfma_f32_16x16x32_bf16 v[76:79], a[204:207], v[144:147], v[76:79]
    s_waitcnt vmcnt(14)
    v_mfma_f32_16x16x32_bf16 v[80:83], a[192:195], v[148:151], v[80:83]
    ds_read_b64_tr_b16 a[56:57], v240 offset:24576
    v_mfma_f32_16x16x32_bf16 v[84:87], a[196:199], v[148:151], v[84:87]
    ds_read_b64_tr_b16 a[58:59], v240 offset:25600
    v_mfma_f32_16x16x32_bf16 v[88:91], a[200:203], v[148:151], v[88:91]
    buffer_load_dwordx4 v235, s[32:35], s18 offen offset:1024 lds
    v_mfma_f32_16x16x32_bf16 v[92:95], a[204:207], v[148:151], v[92:95]
    ds_read_b64_tr_b16 a[60:61], v241 offset:24576
    s_add_u32 m0, s56, 122880
    v_mfma_f32_16x16x32_bf16 v[64:67], a[208:211], v[152:155], v[64:67]
    ds_read_b64_tr_b16 a[62:63], v241 offset:25600
    v_mfma_f32_16x16x32_bf16 v[68:71], a[212:215], v[152:155], v[68:71]
    ds_read_b64_tr_b16 a[64:65], v238 offset:40960
    v_mfma_f32_16x16x32_bf16 v[72:75], a[216:219], v[152:155], v[72:75]
    buffer_load_dwordx4 v234, s[32:35], s19 offen lds
    v_mfma_f32_16x16x32_bf16 v[76:79], a[220:223], v[152:155], v[76:79]
    ds_read_b64_tr_b16 a[66:67], v238 offset:41984
    s_waitcnt lgkmcnt(10)
    v_mfma_f32_16x16x32_bf16 v[80:83], a[208:211], v[156:159], v[80:83]
    ds_read_b64_tr_b16 a[68:69], v239 offset:40960
    s_add_u32 s18, s10, 917504
    v_mfma_f32_16x16x32_bf16 v[84:87], a[212:215], v[156:159], v[84:87]
    ds_read_b64_tr_b16 a[70:71], v239 offset:41984
    v_mfma_f32_16x16x32_bf16 v[88:91], a[216:219], v[156:159], v[88:91]
    v_mfma_f32_16x16x32_bf16 v[92:95], a[220:223], v[156:159], v[92:95]
    s_waitcnt lgkmcnt(11)
    v_mfma_f32_16x16x32_bf16 v[64:67], a[224:227], v[160:163], v[64:67]
    s_waitcnt lgkmcnt(8)
    s_barrier
    ds_read_b128 v[128:131], v246 offset:0
    v_mfma_f32_16x16x32_bf16 v[68:71], a[228:231], v[160:163], v[68:71]
    ds_read_b128 v[132:135], v246 offset:2048
    v_mfma_f32_16x16x32_bf16 v[72:75], a[232:235], v[160:163], v[72:75]
    ds_read_b128 v[136:139], v247 offset:0
    v_mfma_f32_16x16x32_bf16 v[76:79], a[236:239], v[160:163], v[76:79]
    ds_read_b128 v[140:143], v247 offset:2048
    s_waitcnt lgkmcnt(8)
    v_mfma_f32_16x16x32_bf16 v[80:83], a[224:227], v[164:167], v[80:83]
    ds_read_b128 v[144:147], v244 offset:0
    v_mfma_f32_16x16x32_bf16 v[84:87], a[228:231], v[164:167], v[84:87]
    buffer_load_dwordx4 v235, s[32:35], s19 offen offset:1024 lds
    v_mfma_f32_16x16x32_bf16 v[88:91], a[232:235], v[164:167], v[88:91]
    s_add_u32 m0, s56, 57344
    v_mfma_f32_16x16x32_bf16 v[92:95], a[236:239], v[164:167], v[92:95]
    s_waitcnt vmcnt(11)
    s_mov_b64 exec, 1
    buffer_store_dwordx2 v[248:249], off, s[44:47], s71 offset:128 sc1
    s_mov_b64 exec, -1
    s_waitcnt lgkmcnt(5)
    v_mfma_f32_16x16x32_bf16 v[64:67], a[240:243], v[168:171], v[64:67]
    ds_read_b128 v[148:151], v244 offset:2048
    v_mfma_f32_16x16x32_bf16 v[68:71], a[244:247], v[168:171], v[68:71]
    buffer_load_dwordx4 v234, s[32:35], s18 offen lds
    v_mfma_f32_16x16x32_bf16 v[72:75], a[248:251], v[168:171], v[72:75]
    ds_read_b64_tr_b16 a[72:73], v238 offset:32768
    s_add_u32 s19, s10, 983040
    v_mfma_f32_16x16x32_bf16 v[76:79], a[252:255], v[168:171], v[76:79]
    ds_read_b64_tr_b16 a[74:75], v238 offset:33792
    v_mfma_f32_16x16x32_bf16 v[80:83], a[240:243], v[172:175], v[80:83]
    ds_read_b128 v[152:155], v245 offset:0
    v_mfma_f32_16x16x32_bf16 v[84:87], a[244:247], v[172:175], v[84:87]
    buffer_load_dwordx4 v235, s[32:35], s18 offen offset:1024 lds
    v_mfma_f32_16x16x32_bf16 v[88:91], a[248:251], v[172:175], v[88:91]
    ds_read_b64_tr_b16 a[76:77], v239 offset:32768
    s_add_u32 m0, s56, 106496
    v_mfma_f32_16x16x32_bf16 v[92:95], a[252:255], v[172:175], v[92:95]
    ds_read_b64_tr_b16 a[78:79], v239 offset:33792
    s_waitcnt vmcnt(8) lgkmcnt(10)
    v_pk_mul_f32 v[72:73], v[64:65], v[72:73]
    v_pk_mul_f32 v[74:75], v[66:67], v[74:75]
    v_pk_mul_f32 v[76:77], v[68:69], v[76:77]
    v_pk_mul_f32 v[78:79], v[70:71], v[78:79]
    v_pk_mul_f32 v[64:65], v[64:65], s[76:77]
    v_pk_mul_f32 v[66:67], v[66:67], s[76:77]
    v_pk_mul_f32 v[68:69], v[68:69], s[76:77]
    v_pk_mul_f32 v[70:71], v[70:71], s[76:77]
    ds_read_b64_tr_b16 a[80:81], v236 offset:40960
    buffer_load_dwordx4 v234, s[32:35], s19 offen lds
    v_exp_f32 v64, v64
    v_exp_f32 v65, v65
    v_exp_f32 v66, v66
    v_exp_f32 v67, v67
    v_exp_f32 v68, v68
    v_exp_f32 v69, v69
    v_exp_f32 v70, v70
    v_exp_f32 v71, v71
    ds_read_b64_tr_b16 a[82:83], v236 offset:41984
    buffer_load_dwordx4 v235, s[32:35], s19 offen offset:1024 lds
    v_pk_add_f32 v[64:65], v[64:65], s[78:79]
    v_pk_add_f32 v[66:67], v[66:67], s[78:79]
    v_pk_add_f32 v[68:69], v[68:69], s[78:79]
    v_pk_add_f32 v[70:71], v[70:71], s[78:79]
    v_rcp_f32 v64, v64
    v_rcp_f32 v65, v65
    v_rcp_f32 v66, v66
    v_rcp_f32 v67, v67
    ds_read_b64_tr_b16 a[84:85], v237 offset:40960
    s_add_u32 m0, s56, 155648
    s_bfe_u32 s10, s58, 0x40018
    s_lshl_b32 s10, s10, 17
    s_add_u32 s10, s10, s69
    s_add_u32 s18, s10, 0
    buffer_load_dwordx4 v234, s[32:35], s18 offen lds
    v_rcp_f32 v68, v68
    v_rcp_f32 v69, v69
    v_rcp_f32 v70, v70
    v_rcp_f32 v71, v71
    s_add_u32 s61, s70, 524288
    v_pk_mul_f32 v[72:73], v[72:73], v[64:65]
    v_pk_mul_f32 v[74:75], v[74:75], v[66:67]
    v_pk_mul_f32 v[76:77], v[76:77], v[68:69]
    v_pk_mul_f32 v[78:79], v[78:79], v[70:71]
    ds_read_b64_tr_b16 a[86:87], v237 offset:41984
    buffer_load_dwordx4 v235, s[32:35], s18 offen offset:1024 lds
    v_cvt_pk_bf16_f32 v64, v72, v73
    v_cvt_pk_bf16_f32 v65, v74, v75
    v_cvt_pk_bf16_f32 v66, v76, v77
    v_cvt_pk_bf16_f32 v67, v78, v79
    buffer_store_dwordx4 v[64:67], v252, s[44:47], s61 offen sc1
    v_pk_mul_f32 v[88:89], v[80:81], v[88:89]
    v_pk_mul_f32 v[90:91], v[82:83], v[90:91]
    v_pk_mul_f32 v[92:93], v[84:85], v[92:93]
    v_pk_mul_f32 v[94:95], v[86:87], v[94:95]
L_ST4:
    s_cbranch_execz L_WALKED
L_D1_20:
    s_cbranch_execz L_DW1
    v_pk_mul_f32 v[80:81], v[80:81], s[76:77]
    v_pk_mul_f32 v[82:83], v[82:83], s[76:77]
    v_pk_mul_f32 v[84:85], v[84:85], s[76:77]
    v_pk_mul_f32 v[86:87], v[86:87], s[76:77]
    ds_read_b64_tr_b16 a[88:89], v236 offset:32768
    v_exp_f32 v80, v80
    v_exp_f32 v81, v81
    v_exp_f32 v82, v82
    v_exp_f32 v83, v83
    v_exp_f32 v84, v84
    v_exp_f32 v85, v85
    v_exp_f32 v86, v86
    v_exp_f32 v87, v87
    ds_read_b64_tr_b16 a[90:91], v236 offset:33792
    s_add_u32 m0, s56, 8192
    s_add_u32 s19, s10, 65536
    buffer_load_dwordx4 v234, s[32:35], s19 offen lds
    v_pk_add_f32 v[80:81], v[80:81], s[78:79]
    v_pk_add_f32 v[82:83], v[82:83], s[78:79]
    v_pk_add_f32 v[84:85], v[84:85], s[78:79]
    v_pk_add_f32 v[86:87], v[86:87], s[78:79]
    v_rcp_f32 v80, v80
    v_rcp_f32 v81, v81
    v_rcp_f32 v82, v82
    v_rcp_f32 v83, v83
    ds_read_b64_tr_b16 a[92:93], v237 offset:32768
    buffer_load_dwordx4 v235, s[32:35], s19 offen offset:1024 lds
    v_rcp_f32 v84, v84
    v_rcp_f32 v85, v85
    v_rcp_f32 v86, v86
    v_rcp_f32 v87, v87
    s_add_u32 s61, s70, 540672
    v_pk_mul_f32 v[88:89], v[88:89], v[80:81]
    v_pk_mul_f32 v[90:91], v[90:91], v[82:83]
    v_pk_mul_f32 v[92:93], v[92:93], v[84:85]
    v_pk_mul_f32 v[94:95], v[94:95], v[86:87]
    v_cvt_pk_bf16_f32 v80, v88, v89
    v_cvt_pk_bf16_f32 v81, v90, v91
    v_cvt_pk_bf16_f32 v82, v92, v93
    ds_read_b64_tr_b16 a[94:95], v237 offset:33792
    v_cvt_pk_bf16_f32 v83, v94, v95
    buffer_store_dwordx4 v[80:83], v252, s[44:47], s61 offen sc1
    v_mfma_f32_16x16x32_bf16 v[96:99], a[128:131], v[128:131], v[96:99]
    ds_read_b128 v[156:159], v245 offset:2048
    s_add_u32 s18, s10, 917504
    v_mfma_f32_16x16x32_bf16 v[100:103], a[132:135], v[128:131], v[100:103]
    ds_read_b64_tr_b16 a[96:97], v236 offset:49152
    s_add_u32 m0, s56, 139264
    v_mfma_f32_16x16x32_bf16 v[104:107], a[136:139], v[128:131], v[104:107]
    ds_read_b64_tr_b16 a[98:99], v236 offset:50176
    v_mfma_f32_16x16x32_bf16 v[108:111], a[140:143], v[128:131], v[108:111]
    ds_read_b64_tr_b16 a[100:101], v237 offset:49152
    s_waitcnt vmcnt(13) lgkmcnt(15)
    v_mfma_f32_16x16x32_bf16 v[112:115], a[128:131], v[132:135], v[112:115]
    ds_read_b128 v[160:163], v244 offset:8192
    v_mfma_f32_16x16x32_bf16 v[116:119], a[132:135], v[132:135], v[116:119]
    buffer_load_dwordx4 v234, s[32:35], s18 offen lds
    v_mfma_f32_16x16x32_bf16 v[120:123], a[136:139], v[132:135], v[120:123]
    ds_read_b64_tr_b16 a[102:103], v237 offset:50176
    s_add_u32 s19, s10, 983040
    v_mfma_f32_16x16x32_bf16 v[124:127], a[140:143], v[132:135], v[124:127]
    ds_read_b64_tr_b16 a[104:105], v238 offset:49152
    v_mfma_f32_16x16x32_bf16 v[96:99], a[144:147], v[136:139], v[96:99]
    ds_read_b128 v[164:167], v244 offset:10240
    v_mfma_f32_16x16x32_bf16 v[100:103], a[148:151], v[136:139], v[100:103]
    buffer_load_dwordx4 v235, s[32:35], s18 offen offset:1024 lds
    v_mfma_f32_16x16x32_bf16 v[104:107], a[152:155], v[136:139], v[104:107]
    ds_read_b64_tr_b16 a[106:107], v238 offset:50176
    s_add_u32 m0, s56, 24576
    v_mfma_f32_16x16x32_bf16 v[108:111], a[156:159], v[136:139], v[108:111]
    ds_read_b64_tr_b16 a[108:109], v239 offset:49152
    s_waitcnt vmcnt(13) lgkmcnt(10)
    v_mfma_f32_16x16x32_bf16 v[112:115], a[144:147], v[140:143], v[112:115]
    ds_read_b128 v[168:171], v245 offset:8192
    v_mfma_f32_16x16x32_bf16 v[116:119], a[148:151], v[140:143], v[116:119]
    buffer_load_dwordx4 v234, s[32:35], s19 offen lds
    v_mfma_f32_16x16x32_bf16 v[120:123], a[152:155], v[140:143], v[120:123]
    v_cmp_ne_u64 vcc, v[250:251], s[96:97]
    s_mov_b32 s68, s73
    s_cbranch_vccnz L_SF0
L_SR0:
    v_mfma_f32_16x16x32_bf16 v[124:127], a[156:159], v[140:143], v[124:127]
    ds_read_b64_tr_b16 a[110:111], v239 offset:50176
    s_waitcnt lgkmcnt(6)
    v_mfma_f32_16x16x32_bf16 v[96:99], a[160:163], v[144:147], v[96:99]
    ds_read_b128 v[172:175], v245 offset:10240
    s_bfe_u32 s16, s49, 0x40000
    v_mfma_f32_16x16x32_bf16 v[100:103], a[164:167], v[144:147], v[100:103]
    buffer_load_dwordx4 v235, s[32:35], s19 offen offset:1024 lds
    v_mfma_f32_16x16x32_bf16 v[104:107], a[168:171], v[144:147], v[104:107]
    s_lshl_b32 s16, s16, 11
    s_add_u32 s16, s16, s68
    s_add_u32 m0, s56, 49152
    v_mfma_f32_16x16x32_bf16 v[108:111], a[172:175], v[144:147], v[108:111]
    ds_read_b64_tr_b16 a[112:113], v240 offset:16384
    v_mfma_f32_16x16x32_bf16 v[112:115], a[160:163], v[148:151], v[112:115]
    ds_read_b128 v[128:131], v242 offset:0
    v_mfma_f32_16x16x32_bf16 v[116:119], a[164:167], v[148:151], v[116:119]
    buffer_load_dwordx4 v252, s[44:47], s16 offen lds
    v_mfma_f32_16x16x32_bf16 v[120:123], a[168:171], v[148:151], v[120:123]
    ds_read_b64_tr_b16 a[114:115], v240 offset:17408
    s_bfe_u32 s17, s49, 0x40004
    v_mfma_f32_16x16x32_bf16 v[124:127], a[172:175], v[148:151], v[124:127]
    ds_read_b64_tr_b16 a[116:117], v241 offset:16384
    s_lshl_b32 s17, s17, 11
    v_mfma_f32_16x16x32_bf16 v[96:99], a[176:179], v[152:155], v[96:99]
    ds_read_b128 v[132:135], v242 offset:2048
    s_add_u32 s17, s17, s68
    v_mfma_f32_16x16x32_bf16 v[100:103], a[180:183], v[152:155], v[100:103]
    buffer_load_dwordx4 v252, s[44:47], s16 offen offset:1024 lds
    v_mfma_f32_16x16x32_bf16 v[104:107], a[184:187], v[152:155], v[104:107]
    ds_read_b64_tr_b16 a[118:119], v241 offset:17408
    s_add_u32 m0, s56, 98304
    v_mfma_f32_16x16x32_bf16 v[108:111], a[188:191], v[152:155], v[108:111]
    ds_read_b64_tr_b16 a[120:121], v238 offset:57344
    s_waitcnt lgkmcnt(8)
    v_mfma_f32_16x16x32_bf16 v[112:115], a[176:179], v[156:159], v[112:115]
    ds_read_b128 v[136:139], v243 offset:0
    v_mfma_f32_16x16x32_bf16 v[116:119], a[180:183], v[156:159], v[116:119]
    buffer_load_dwordx2 v[250:251], v253, s[44:47], s72 offen offset:128 sc1
    v_mfma_f32_16x16x32_bf16 v[120:123], a[184:187], v[156:159], v[120:123]
    ds_read_b64_tr_b16 a[122:123], v238 offset:58368
    v_mfma_f32_16x16x32_bf16 v[124:127], a[188:191], v[156:159], v[124:127]
    ds_read_b64_tr_b16 a[124:125], v239 offset:57344
    v_mfma_f32_16x16x32_bf16 v[96:99], a[192:195], v[160:163], v[96:99]
    ds_read_b128 v[140:143], v243 offset:2048
    v_mfma_f32_16x16x32_bf16 v[100:103], a[196:199], v[160:163], v[100:103]
    ds_read_b64_tr_b16 a[126:127], v239 offset:58368
    v_mfma_f32_16x16x32_bf16 v[104:107], a[200:203], v[160:163], v[104:107]
    buffer_load_dwordx4 v252, s[44:47], s17 offen lds
    v_mfma_f32_16x16x32_bf16 v[108:111], a[204:207], v[160:163], v[108:111]
    s_bfe_u32 s16, s49, 0x40008
    s_lshl_b32 s16, s16, 11
    s_waitcnt lgkmcnt(6)
    v_mfma_f32_16x16x32_bf16 v[112:115], a[192:195], v[164:167], v[112:115]
    s_add_u32 s16, s16, s68
    v_mfma_f32_16x16x32_bf16 v[116:119], a[196:199], v[164:167], v[116:119]
    v_mfma_f32_16x16x32_bf16 v[120:123], a[200:203], v[164:167], v[120:123]
    buffer_load_dwordx4 v252, s[44:47], s17 offen offset:1024 lds
    v_mfma_f32_16x16x32_bf16 v[124:127], a[204:207], v[164:167], v[124:127]
    s_add_u32 m0, s56, 114688
    s_waitcnt vmcnt(15)
    v_mfma_f32_16x16x32_bf16 v[96:99], a[208:211], v[168:171], v[96:99]
    ds_read_b64_tr_b16 v[0:1], v236 offset:57344
    v_mfma_f32_16x16x32_bf16 v[100:103], a[212:215], v[168:171], v[100:103]
    ds_read_b64_tr_b16 v[2:3], v236 offset:58368
    v_mfma_f32_16x16x32_bf16 v[104:107], a[216:219], v[168:171], v[104:107]
    ds_read_b64_tr_b16 v[4:5], v237 offset:57344
    v_mfma_f32_16x16x32_bf16 v[108:111], a[220:223], v[168:171], v[108:111]
    ds_read_b64_tr_b16 v[6:7], v237 offset:58368
    s_waitcnt vmcnt(13) lgkmcnt(4)
    v_mfma_f32_16x16x32_bf16 v[112:115], a[208:211], v[172:175], v[112:115]
    buffer_load_dwordx4 v252, s[44:47], s16 offen lds
    v_mfma_f32_16x16x32_bf16 v[116:119], a[212:215], v[172:175], v[116:119]
    ds_read_b64_tr_b16 v[8:9], v238 offset:40960
    s_bfe_u32 s17, s49, 0x4000c
    v_mfma_f32_16x16x32_bf16 v[120:123], a[216:219], v[172:175], v[120:123]
    ds_read_b64_tr_b16 v[10:11], v238 offset:41984
    s_lshl_b32 s17, s17, 11
    v_mfma_f32_16x16x32_bf16 v[124:127], a[220:223], v[172:175], v[124:127]
    buffer_load_dwordx4 v252, s[44:47], s16 offen offset:1024 lds
    v_mfma_f32_16x16x32_bf16 v[96:99], a[224:227], v[128:131], v[96:99]
    s_add_u32 s17, s17, s68
    s_add_u32 m0, s56, 122880
    v_mfma_f32_16x16x32_bf16 v[100:103], a[228:231], v[128:131], v[100:103]
    ds_read_b64_tr_b16 v[12:13], v239 offset:40960
    v_mfma_f32_16x16x32_bf16 v[104:107], a[232:235], v[128:131], v[104:107]
    ds_read_b64_tr_b16 v[14:15], v239 offset:41984
    v_mfma_f32_16x16x32_bf16 v[108:111], a[236:239], v[128:131], v[108:111]
    buffer_load_dwordx4 v252, s[44:47], s17 offen lds
    v_mfma_f32_16x16x32_bf16 v[112:115], a[224:227], v[132:135], v[112:115]
    ds_read_b64_tr_b16 v[16:17], v240 offset:24576
    s_bfe_u32 s16, s49, 0x40010
    v_mfma_f32_16x16x32_bf16 v[116:119], a[228:231], v[132:135], v[116:119]
    ds_read_b64_tr_b16 v[18:19], v240 offset:25600
    s_lshl_b32 s16, s16, 11
    v_mfma_f32_16x16x32_bf16 v[120:123], a[232:235], v[132:135], v[120:123]
    ds_read_b64_tr_b16 v[20:21], v241 offset:24576
    s_add_u32 s16, s16, s68
    v_mfma_f32_16x16x32_bf16 v[124:127], a[236:239], v[132:135], v[124:127]
    s_waitcnt vmcnt(12)
    s_mov_b64 exec, 1
    buffer_store_dwordx2 v[248:249], off, s[44:47], s71 offset:256 sc1
    s_mov_b64 exec, -1
    s_waitcnt lgkmcnt(7)
    v_mfma_f32_16x16x32_bf16 v[96:99], a[240:243], v[136:139], v[96:99]
    buffer_load_dwordx4 v252, s[44:47], s17 offen offset:1024 lds
    v_mfma_f32_16x16x32_bf16 v[100:103], a[244:247], v[136:139], v[100:103]
    ds_read_b64_tr_b16 v[22:23], v241 offset:25600
    s_add_u32 m0, s56, 147456
    v_mfma_f32_16x16x32_bf16 v[104:107], a[248:251], v[136:139], v[104:107]
    ds_read_b64_tr_b16 v[24:25], v236 offset:8192
    v_mfma_f32_16x16x32_bf16 v[108:111], a[252:255], v[136:139], v[108:111]
    ds_read_b64_tr_b16 v[26:27], v236 offset:9216
    s_waitcnt lgkmcnt(6)
    v_mfma_f32_16x16x32_bf16 v[112:115], a[240:243], v[140:143], v[112:115]
    buffer_load_dwordx4 v252, s[44:47], s16 offen lds
    v_mfma_f32_16x16x32_bf16 v[116:119], a[244:247], v[140:143], v[116:119]
    ds_read_b64_tr_b16 v[28:29], v237 offset:8192
    s_bfe_u32 s17, s49, 0x40014
    v_mfma_f32_16x16x32_bf16 v[120:123], a[248:251], v[140:143], v[120:123]
    ds_read_b64_tr_b16 v[30:31], v237 offset:9216
    s_lshl_b32 s17, s17, 11
    v_mfma_f32_16x16x32_bf16 v[124:127], a[252:255], v[140:143], v[124:127]
    buffer_load_dwordx4 v252, s[44:47], s16 offen offset:1024 lds
    s_add_u32 m0, s56, 106496
    s_add_u32 s17, s17, s68
    buffer_load_dwordx4 v252, s[44:47], s17 offen lds
    buffer_load_dwordx4 v252, s[44:47], s17 offen offset:1024 lds
L_JOIN:
    s_cmp_lg_u32 s68, s73
    s_cbranch_scc1 L_FIX0_0
L_FOK0_0:
    v_pk_mul_f32 v[104:105], v[96:97], v[104:105]
    v_pk_mul_f32 v[106:107], v[98:99], v[106:107]
    v_pk_mul_f32 v[108:109], v[100:101], v[108:109]
    v_pk_mul_f32 v[110:111], v[102:103], v[110:111]
    v_pk_mul_f32 v[96:97], v[96:97], s[76:77]
    v_pk_mul_f32 v[98:99], v[98:99], s[76:77]
    v_pk_mul_f32 v[100:101], v[100:101], s[76:77]
    v_pk_mul_f32 v[102:103], v[102:103], s[76:77]
    v_exp_f32 v96, v96
    v_exp_f32 v97, v97
    v_exp_f32 v98, v98
    v_exp_f32 v99, v99
    v_exp_f32 v100, v100
    v_exp_f32 v101, v101
    v_exp_f32 v102, v102
    v_exp_f32 v103, v103
    s_add_u32 m0, s56, 57344
    s_bfe_u32 s16, s49, 0x40018
    s_lshl_b32 s16, s16, 11
    s_add_u32 s16, s16, s68
    buffer_load_dwordx4 v252, s[44:47], s16 offen lds
    v_pk_add_f32 v[96:97], v[96:97], s[78:79]
    v_pk_add_f32 v[98:99], v[98:99], s[78:79]
    v_pk_add_f32 v[100:101], v[100:101], s[78:79]
    v_pk_add_f32 v[102:103], v[102:103], s[78:79]
    v_rcp_f32 v96, v96
    v_rcp_f32 v97, v97
    v_rcp_f32 v98, v98
    v_rcp_f32 v99, v99
    s_cmp_lg_u32 s68, s73
    s_cbranch_scc1 L_FIX0
L_FOK0:
    s_waitcnt vmcnt(10)
    s_barrier
    ds_read_b128 v[144:147], v252 offset:49152
    ds_read_b128 v[148:151], v252 offset:51200
    buffer_load_dwordx4 v252, s[44:47], s16 offen offset:1024 lds
    v_rcp_f32 v100, v100
    v_rcp_f32 v101, v101
    v_rcp_f32 v102, v102
    v_rcp_f32 v103, v103
    s_add_u32 s61, s70, 786432
    v_pk_mul_f32 v[104:105], v[104:105], v[96:97]
    v_pk_mul_f32 v[106:107], v[106:107], v[98:99]
    v_pk_mul_f32 v[108:109], v[108:109], v[100:101]
    v_pk_mul_f32 v[110:111], v[110:111], v[102:103]
    ds_read_b128 v[152:155], v252 offset:50176
    ds_read_b128 v[156:159], v252 offset:52224
    v_cvt_pk_bf16_f32 v96, v104, v105
    v_cvt_pk_bf16_f32 v97, v106, v107
    v_cvt_pk_bf16_f32 v98, v108, v109
    v_cvt_pk_bf16_f32 v99, v110, v111
    buffer_store_dwordx4 v[96:99], v252, s[44:47], s61 offen sc1
    v_pk_mul_f32 v[120:121], v[112:113], v[120:121]
    v_pk_mul_f32 v[122:123], v[114:115], v[122:123]
    v_pk_mul_f32 v[124:125], v[116:117], v[124:125]
    v_pk_mul_f32 v[126:127], v[118:119], v[126:127]
    v_pk_mul_f32 v[112:113], v[112:113], s[76:77]
    v_pk_mul_f32 v[114:115], v[114:115], s[76:77]
    v_pk_mul_f32 v[116:117], v[116:117], s[76:77]
    v_pk_mul_f32 v[118:119], v[118:119], s[76:77]
    ds_read_b128 v[160:163], v252 offset:53248
    ds_read_b128 v[164:167], v252 offset:55296
    v_exp_f32 v112, v112
    v_exp_f32 v113, v113
    v_exp_f32 v114, v114
    v_exp_f32 v115, v115
    v_exp_f32 v116, v116
    v_exp_f32 v117, v117
    v_exp_f32 v118, v118
    v_exp_f32 v119, v119
    ds_read_b128 v[168:171], v252 offset:54272
    ds_read_b128 v[172:175], v252 offset:56320
    v_pk_add_f32 v[112:113], v[112:113], s[78:79]
    v_pk_add_f32 v[114:115], v[114:115], s[78:79]
    v_pk_add_f32 v[116:117], v[116:117], s[78:79]
    v_pk_add_f32 v[118:119], v[118:119], s[78:79]
    v_rcp_f32 v112, v112
    v_rcp_f32 v113, v113
    v_rcp_f32 v114, v114
    v_rcp_f32 v115, v115
    ds_read_b128 v[128:131], v228 offset:32768
    ds_read_b128 v[132:135], v228 offset:34816
    v_rcp_f32 v116, v116
    v_rcp_f32 v117, v117
    v_rcp_f32 v118, v118
    v_rcp_f32 v119, v119
    s_add_u32 s61, s70, 802816
    v_pk_mul_f32 v[120:121], v[120:121], v[112:113]
    v_pk_mul_f32 v[122:123], v[122:123], v[114:115]
    v_pk_mul_f32 v[124:125], v[124:125], v[116:117]
    v_pk_mul_f32 v[126:127], v[126:127], v[118:119]
    v_cvt_pk_bf16_f32 v112, v120, v121
    v_cvt_pk_bf16_f32 v113, v122, v123
    v_cvt_pk_bf16_f32 v114, v124, v125
    ds_read_b64_tr_b16 v[32:33], v240 offset:8192
    v_cvt_pk_bf16_f32 v115, v126, v127
    buffer_store_dwordx4 v[112:115], v252, s[44:47], s61 offen sc1
L_D2_0:
    s_cbranch_execz L_DW2
    s_waitcnt lgkmcnt(10)
    v_mfma_f32_16x16x32_bf16 v[64:67], v[176:179], v[144:147], 0
    ds_read_b64_tr_b16 v[34:35], v240 offset:9216
    s_waitcnt lgkmcnt(9)
    v_mfma_f32_16x16x32_bf16 v[68:71], v[180:183], v[144:147], 0
    ds_read_b64_tr_b16 v[36:37], v241 offset:8192
    v_and_b32 v230, 7, v254
    v_mfma_f32_16x16x32_bf16 v[72:75], v[176:179], v[148:151], 0
    ds_read_b128 v[136:139], v228 offset:33792
    v_lshlrev_b32 v230, 2, v230
    v_mfma_f32_16x16x32_bf16 v[76:79], v[180:183], v[148:151], 0
    ds_read_b64_tr_b16 v[38:39], v241 offset:9216
    v_lshrrev_b32 v230, v230, s96
    v_mfma_f32_16x16x32_bf16 v[64:67], v[184:187], v[152:155], v[64:67]
    ds_read_b128 v[140:143], v228 offset:35840
    s_waitcnt lgkmcnt(11)
    v_mfma_f32_16x16x32_bf16 v[68:71], v[188:191], v[152:155], v[68:71]
    ds_read_b64_tr_b16 v[40:41], v236 offset:24576
    v_lshlrev_b32 v227, 6, v230
    v_mfma_f32_16x16x32_bf16 v[72:75], v[184:187], v[156:159], v[72:75]
    ds_read_b128 v[144:147], v228 offset:36864
    v_and_b32 v230, 3, v230
    v_mfma_f32_16x16x32_bf16 v[76:79], v[188:191], v[156:159], v[76:79]
    ds_read_b64_tr_b16 v[42:43], v236 offset:25600
    v_and_b32 v227, 0x300, v227
    v_mfma_f32_16x16x32_bf16 v[64:67], v[192:195], v[160:163], v[64:67]
    ds_read_b128 v[148:151], v228 offset:38912
    s_waitcnt lgkmcnt(13)
    v_mfma_f32_16x16x32_bf16 v[68:71], v[196:199], v[160:163], v[68:71]
    ds_read_b64_tr_b16 v[44:45], v237 offset:24576
    v_or_b32 v227, v227, v230
    v_mfma_f32_16x16x32_bf16 v[72:75], v[192:195], v[164:167], v[72:75]
    ds_read_b128 v[152:155], v228 offset:37888
    v_mul_u32_u24 v224, 12, v254
    v_mfma_f32_16x16x32_bf16 v[76:79], v[196:199], v[164:167], v[76:79]
    ds_read_b64_tr_b16 v[46:47], v237 offset:25600
    v_and_b32 v230, 15, v254
    v_mfma_f32_16x16x32_bf16 v[64:67], v[200:203], v[168:171], v[64:67]
    ds_read_b128 v[156:159], v228 offset:39936
    s_waitcnt lgkmcnt(9)
    v_mfma_f32_16x16x32_bf16 v[68:71], v[204:207], v[168:171], v[68:71]
    v_cmp_ne_u64 vcc, v[250:251], s[96:97]
    s_add_u32 s73, s73, 262144
    s_mov_b32 s68, s73
    s_cbranch_vccnz L_SF1
L_SR1:
    v_mfma_f32_16x16x32_bf16 v[72:75], v[200:203], v[172:175], v[72:75]
    s_waitcnt vmcnt(8)
    s_barrier
    ds_read_b128 v[160:163], v228 offset:49152
    s_bfe_u32 s17, s49, 0x40000
    v_mfma_f32_16x16x32_bf16 v[76:79], v[204:207], v[172:175], v[76:79]
    s_lshl_b32 s17, s17, 11
    s_add_u32 s17, s17, s68
    s_add_u32 m0, s56, 155648
    v_mfma_f32_16x16x32_bf16 v[64:67], v[208:211], v[128:131], v[64:67]
    ds_read_b128 v[164:167], v228 offset:51200
    v_lshlrev_b32 v226, 11, v230
    v_mfma_f32_16x16x32_bf16 v[68:71], v[212:215], v[128:131], v[68:71]
    buffer_load_dwordx4 v252, s[44:47], s17 offen lds
    v_mfma_f32_16x16x32_bf16 v[72:75], v[208:211], v[132:135], v[72:75]
    ds_read_b128 v[168:171], v228 offset:50176
    s_bfe_u32 s16, s49, 0x40004
L_D2_1:
    s_cbranch_execz L_DW2
    v_mfma_f32_16x16x32_bf16 v[76:79], v[212:215], v[132:135], v[76:79]
    s_lshl_b32 s16, s16, 11
    s_add_u32 s16, s16, s68
    v_bfe_u32 v230, v254, 4, 1
    v_mfma_f32_16x16x32_bf16 v[64:67], v[216:219], v[136:139], v[64:67]
    ds_read_b128 v[172:175], v228 offset:52224
    s_waitcnt lgkmcnt(5)
    v_mfma_f32_16x16x32_bf16 v[68:71], v[220:223], v[136:139], v[68:71]
    buffer_load_dwordx4 v252, s[44:47], s17 offen offset:1024 lds
    v_mfma_f32_16x16x32_bf16 v[72:75], v[216:219], v[140:143], v[72:75]
    ds_read_b128 v[128:131], v228 offset:53248
    s_add_u32 m0, s56, 16384
    v_mfma_f32_16x16x32_bf16 v[76:79], v[220:223], v[140:143], v[76:79]
    v_lshl_add_u32 v226, v230, 5, v226
    v_lshrrev_b32 v230, 5, v254
    v_mfma_f32_16x16x32_bf16 v[64:67], a[0:3], v[144:147], v[64:67]
    ds_read_b128 v[132:135], v228 offset:55296
    v_lshl_add_u32 v226, v230, 4, v226
    v_mfma_f32_16x16x32_bf16 v[68:71], a[4:7], v[144:147], v[68:71]
    buffer_load_dwordx4 v252, s[44:47], s16 offen lds
    v_mfma_f32_16x16x32_bf16 v[72:75], a[0:3], v[148:151], v[72:75]
    ds_read_b128 v[136:139], v228 offset:54272
    s_mov_b32 s93, 40000
    v_mfma_f32_16x16x32_bf16 v[76:79], a[4:7], v[148:151], v[76:79]
    s_bfe_u32 s17, s49, 0x40008
    s_lshl_b32 s17, s17, 11
    s_add_u32 s17, s17, s68
    v_mfma_f32_16x16x32_bf16 v[64:67], a[8:11], v[152:155], v[64:67]
    ds_read_b128 v[140:143], v228 offset:56320
    s_waitcnt lgkmcnt(7)
    v_mfma_f32_16x16x32_bf16 v[68:71], a[12:15], v[152:155], v[68:71]
    buffer_load_dwordx4 v252, s[44:47], s16 offen offset:1024 lds
    v_mfma_f32_16x16x32_bf16 v[72:75], a[8:11], v[156:159], v[72:75]
    ds_read_b128 v[144:147], v228 offset:57344
    s_add_u32 m0, s56, 24576
    v_mfma_f32_16x16x32_bf16 v[76:79], a[12:15], v[156:159], v[76:79]
    v_mfma_f32_16x16x32_bf16 v[64:67], a[16:19], v[160:163], v[64:67]
    ds_read_b128 v[148:151], v228 offset:59392
    s_waitcnt lgkmcnt(7)
    v_mfma_f32_16x16x32_bf16 v[68:71], a[20:23], v[160:163], v[68:71]
    buffer_load_dwordx4 v252, s[44:47], s17 offen lds
    v_mfma_f32_16x16x32_bf16 v[72:75], a[16:19], v[164:167], v[72:75]
    ds_read_b128 v[152:155], v228 offset:58368
    s_bfe_u32 s16, s49, 0x4000c
    v_mfma_f32_16x16x32_bf16 v[76:79], a[20:23], v[164:167], v[76:79]
    s_lshl_b32 s16, s16, 11
    s_add_u32 s16, s16, s68
    v_mfma_f32_16x16x32_bf16 v[64:67], a[24:27], v[168:171], v[64:67]
    ds_read_b128 v[156:159], v228 offset:60416
    s_waitcnt lgkmcnt(7)
    v_mfma_f32_16x16x32_bf16 v[68:71], a[28:31], v[168:171], v[68:71]
    buffer_load_dwordx4 v252, s[44:47], s17 offen offset:1024 lds
    v_mfma_f32_16x16x32_bf16 v[72:75], a[24:27], v[172:175], v[72:75]
    ds_read_b128 v[160:163], v228 offset:61440
    s_add_u32 m0, s56, 49152
    v_mfma_f32_16x16x32_bf16 v[76:79], a[28:31], v[172:175], v[76:79]
    v_mfma_f32_16x16x32_bf16 v[64:67], a[32:35], v[128:131], v[64:67]
    ds_read_b128 v[164:167], v228 offset:63488
    s_waitcnt lgkmcnt(7)
    v_mfma_f32_16x16x32_bf16 v[68:71], a[36:39], v[128:131], v[68:71]
    buffer_load_dwordx4 v252, s[44:47], s16 offen lds
    v_mfma_f32_16x16x32_bf16 v[72:75], a[32:35], v[132:135], v[72:75]
    ds_read_b128 v[168:171], v228 offset:62464
    s_bfe_u32 s17, s49, 0x40010
    v_mfma_f32_16x16x32_bf16 v[76:79], a[36:39], v[132:135], v[76:79]
    s_lshl_b32 s17, s17, 11
    s_add_u32 s17, s17, s68
    v_mfma_f32_16x16x32_bf16 v[64:67], a[40:43], v[136:139], v[64:67]
    ds_read_b128 v[172:175], v228 offset:64512
    s_waitcnt lgkmcnt(7)
    v_mfma_f32_16x16x32_bf16 v[68:71], a[44:47], v[136:139], v[68:71]
L_D2_2:
    s_cbranch_execz L_D2_3
    s_waitcnt vmcnt(7)
    s_mov_b64 exec, 1
    buffer_store_dwordx2 v[248:249], off, s[44:47], s71 offset:384 sc1
    s_mov_b64 exec, -1
    v_mfma_f32_16x16x32_bf16 v[72:75], a[40:43], v[140:143], v[72:75]
    s_barrier
    ds_read_b128 v[128:131], v229 offset:16384
    v_mfma_f32_16x16x32_bf16 v[76:79], a[44:47], v[140:143], v[76:79]
    buffer_load_dwordx4 v252, s[44:47], s16 offen offset:1024 lds
    v_mfma_f32_16x16x32_bf16 v[64:67], a[48:51], v[144:147], v[64:67]
    ds_read_b128 v[132:135], v229 offset:18432
    s_waitcnt lgkmcnt(7)
    v_mfma_f32_16x16x32_bf16 v[68:71], a[52:55], v[144:147], v[68:71]
    s_add_u32 m0, s56, 139264
    v_mfma_f32_16x16x32_bf16 v[72:75], a[48:51], v[148:151], v[72:75]
    ds_read_b128 v[136:139], v229 offset:17408
    v_mfma_f32_16x16x32_bf16 v[76:79], a[52:55], v[148:151], v[76:79]
    buffer_load_dwordx4 v252, s[44:47], s17 offen lds
    v_mfma_f32_16x16x32_bf16 v[64:67], a[56:59], v[152:155], v[64:67]
    ds_read_b128 v[140:143], v229 offset:19456
    s_waitcnt lgkmcnt(7)
    v_mfma_f32_16x16x32_bf16 v[68:71], a[60:63], v[152:155], v[68:71]
    s_cmp_lg_u32 s68, s73
    s_cbranch_scc1 L_FIX1_2
L_FOK1_2:
    v_mfma_f32_16x16x32_bf16 v[72:75], a[56:59], v[156:159], v[72:75]
    ds_read_b128 v[144:147], v229 offset:20480
    v_mfma_f32_16x16x32_bf16 v[76:79], a[60:63], v[156:159], v[76:79]
    buffer_load_dwordx2 v[250:251], v253, s[44:47], s72 offen offset:256 sc1
    v_mfma_f32_16x16x32_bf16 v[64:67], a[64:67], v[160:163], v[64:67]
    ds_read_b128 v[148:151], v229 offset:22528
    s_waitcnt lgkmcnt(7)
    v_mfma_f32_16x16x32_bf16 v[68:71], a[68:71], v[160:163], v[68:71]
    buffer_load_dwordx4 v252, s[44:47], s17 offen offset:1024 lds
    v_mfma_f32_16x16x32_bf16 v[72:75], a[64:67], v[164:167], v[72:75]
    ds_read_b128 v[152:155], v229 offset:21504
    v_mfma_f32_16x16x32_bf16 v[76:79], a[68:71], v[164:167], v[76:79]
    v_mfma_f32_16x16x32_bf16 v[64:67], a[72:75], v[168:171], v[64:67]
    ds_read_b128 v[156:159], v229 offset:23552
    s_waitcnt lgkmcnt(7)
    v_mfma_f32_16x16x32_bf16 v[68:71], a[76:79], v[168:171], v[68:71]
    s_bfe_u32 s16, s49, 0x40014
    s_lshl_b32 s16, s16, 11
    s_add_u32 s16, s16, s68
    v_mfma_f32_16x16x32_bf16 v[72:75], a[72:75], v[172:175], v[72:75]
    ds_read_b128 v[160:163], v228 offset:40960
    s_add_u32 m0, s56, 131072
    v_mfma_f32_16x16x32_bf16 v[76:79], a[76:79], v[172:175], v[76:79]
    v_mfma_f32_16x16x32_bf16 v[64:67], a[80:83], v[128:131], v[64:67]
    ds_read_b128 v[164:167], v228 offset:43008
    s_waitcnt lgkmcnt(7)
    v_mfma_f32_16x16x32_bf16 v[68:71], a[84:87], v[128:131], v[68:71]
    buffer_load_dwordx4 v252, s[44:47], s16 offen lds
    v_mfma_f32_16x16x32_bf16 v[72:75], a[80:83], v[132:135], v[72:75]
    ds_read_b128 v[168:171], v228 offset:41984
    s_bfe_u32 s17, s49, 0x40018
    v_mfma_f32_16x16x32_bf16 v[76:79], a[84:87], v[132:135], v[76:79]
    s_lshl_b32 s17, s17, 11
    s_add_u32 s17, s17, s68
    v_mfma_f32_16x16x32_bf16 v[64:67], a[88:91], v[136:139], v[64:67]
    ds_read_b128 v[172:175], v228 offset:44032
    s_waitcnt lgkmcnt(7)
    v_mfma_f32_16x16x32_bf16 v[68:71], a[92:95], v[136:139], v[68:71]
    buffer_load_dwordx4 v252, s[44:47], s16 offen offset:1024 lds
    v_mfma_f32_16x16x32_bf16 v[72:75], a[88:91], v[140:143], v[72:75]
    ds_read_b128 v[128:131], v228 offset:45056
    s_add_u32 m0, s56, 98304
    v_mfma_f32_16x16x32_bf16 v[76:79], a[92:95], v[140:143], v[76:79]
    v_mfma_f32_16x16x32_bf16 v[64:67], a[96:99], v[144:147], v[64:67]
    ds_read_b128 v[132:135], v228 offset:47104
    s_waitcnt lgkmcnt(7)
    v_mfma_f32_16x16x32_bf16 v[68:71], a[100:103], v[144:147], v[68:71]
    buffer_load_dwordx4 v252, s[44:47], s17 offen lds
L_D2_3:
    s_cbranch_execz L_DW2
    v_mfma_f32_16x16x32_bf16 v[72:75], a[96:99], v[148:151], v[72:75]
    ds_read_b128 v[136:139], v228 offset:46080
    v_mfma_f32_16x16x32_bf16 v[76:79], a[100:103], v[148:151], v[76:79]
    v_mfma_f32_16x16x32_bf16 v[64:67], a[104:107], v[152:155], v[64:67]
    ds_read_b128 v[140:143], v228 offset:48128
    s_waitcnt lgkmcnt(7)
    v_mfma_f32_16x16x32_bf16 v[68:71], a[108:111], v[152:155], v[68:71]
    s_cmp_lg_u32 s68, s73
    s_cbranch_scc1 L_FIX1
L_FOK1:
    v_mfma_f32_16x16x32_bf16 v[72:75], a[104:107], v[156:159], v[72:75]
    s_waitcnt vmcnt(13)
    s_barrier
    ds_read_b128 v[144:147], v252 offset:57344
    v_mfma_f32_16x16x32_bf16 v[76:79], a[108:111], v[156:159], v[76:79]
    buffer_load_dwordx4 v252, s[44:47], s17 offen offset:1024 lds
    v_mfma_f32_16x16x32_bf16 v[64:67], a[112:115], v[160:163], v[64:67]
    ds_read_b128 v[148:151], v252 offset:59392
    s_waitcnt lgkmcnt(7)
    v_mfma_f32_16x16x32_bf16 v[68:71], a[116:119], v[160:163], v[68:71]
    v_mfma_f32_16x16x32_bf16 v[72:75], a[112:115], v[164:167], v[72:75]
    ds_read_b128 v[152:155], v252 offset:58368
    v_mfma_f32_16x16x32_bf16 v[76:79], a[116:119], v[164:167], v[76:79]
    v_mfma_f32_16x16x32_bf16 v[64:67], a[120:123], v[168:171], v[64:67]
    ds_read_b128 v[156:159], v252 offset:60416
    s_waitcnt lgkmcnt(7)
    v_mfma_f32_16x16x32_bf16 v[68:71], a[124:127], v[168:171], v[68:71]
    v_mfma_f32_16x16x32_bf16 v[72:75], a[120:123], v[172:175], v[72:75]
    ds_read_b128 v[160:163], v252 offset:61440
    v_mfma_f32_16x16x32_bf16 v[76:79], a[124:127], v[172:175], v[76:79]
    v_mfma_f32_16x16x32_bf16 v[64:67], v[0:3], v[128:131], v[64:67]
    ds_read_b128 v[164:167], v252 offset:63488
    s_waitcnt lgkmcnt(7)
    v_mfma_f32_16x16x32_bf16 v[68:71], v[4:7], v[128:131], v[68:71]
    v_mfma_f32_16x16x32_bf16 v[72:75], v[0:3], v[132:135], v[72:75]
    ds_read_b128 v[168:171], v252 offset:62464
    v_mfma_f32_16x16x32_bf16 v[76:79], v[4:7], v[132:135], v[76:79]
    v_mfma_f32_16x16x32_bf16 v[64:67], v[8:11], v[136:139], v[64:67]
    ds_read_b128 v[172:175], v252 offset:64512
    s_waitcnt lgkmcnt(7)
    v_mfma_f32_16x16x32_bf16 v[68:71], v[12:15], v[136:139], v[68:71]
    v_mfma_f32_16x16x32_bf16 v[72:75], v[8:11], v[140:143], v[72:75]
    ds_read_b128 v[128:131], v229 offset:24576
    v_mfma_f32_16x16x32_bf16 v[76:79], v[12:15], v[140:143], v[76:79]
    v_mfma_f32_16x16x32_bf16 v[64:67], v[16:19], v[144:147], v[64:67]
    ds_read_b128 v[132:135], v229 offset:26624
    s_waitcnt lgkmcnt(7)
    v_mfma_f32_16x16x32_bf16 v[68:71], v[20:23], v[144:147], v[68:71]
    v_mfma_f32_16x16x32_bf16 v[72:75], v[16:19], v[148:151], v[72:75]
    ds_read_b128 v[136:139], v229 offset:25600
    v_mfma_f32_16x16x32_bf16 v[76:79], v[20:23], v[148:151], v[76:79]
    v_mfma_f32_16x16x32_bf16 v[64:67], v[24:27], v[152:155], v[64:67]
    ds_read_b128 v[140:143], v229 offset:27648
    s_waitcnt lgkmcnt(7)
    v_mfma_f32_16x16x32_bf16 v[68:71], v[28:31], v[152:155], v[68:71]
    v_mfma_f32_16x16x32_bf16 v[72:75], v[24:27], v[156:159], v[72:75]
    ds_read_b128 v[144:147], v229 offset:28672
    v_mfma_f32_16x16x32_bf16 v[76:79], v[28:31], v[156:159], v[76:79]
    v_mfma_f32_16x16x32_bf16 v[64:67], v[32:35], v[160:163], v[64:67]
    ds_read_b128 v[148:151], v229 offset:30720
    s_waitcnt lgkmcnt(7)
    v_mfma_f32_16x16x32_bf16 v[68:71], v[36:39], v[160:163], v[68:71]
    v_mfma_f32_16x16x32_bf16 v[72:75], v[32:35], v[164:167], v[72:75]
    ds_read_b128 v[152:155], v229 offset:29696
    v_mfma_f32_16x16x32_bf16 v[76:79], v[36:39], v[164:167], v[76:79]
    v_mfma_f32_16x16x32_bf16 v[64:67], v[40:43], v[168:171], v[64:67]
    ds_read_b128 v[156:159], v229 offset:31744
    s_waitcnt lgkmcnt(7)
    v_mfma_f32_16x16x32_bf16 v[68:71], v[44:47], v[168:171], v[68:71]
    v_mfma_f32_16x16x32_bf16 v[72:75], v[40:43], v[172:175], v[72:75]
    s_waitcnt vmcnt(10)
L_ST5:
    s_cbranch_execz L_WALKED
L_D1_24:
    s_cbranch_execz L_DW1
L_D2_4:
    s_cbranch_execz L_DW2
    s_barrier
    ds_read_b128 v[160:163], v252 offset:16384
    v_mfma_f32_16x16x32_bf16 v[76:79], v[44:47], v[172:175], v[76:79]
    v_mfma_f32_16x16x32_bf16 v[80:83], v[176:179], v[128:131], 0
    ds_read_b128 v[164:167], v252 offset:18432
    s_waitcnt lgkmcnt(7)
    v_mfma_f32_16x16x32_bf16 v[84:87], v[180:183], v[128:131], 0
    v_mfma_f32_16x16x32_bf16 v[88:91], v[176:179], v[132:135], 0
    ds_read_b128 v[168:171], v252 offset:17408
    v_mfma_f32_16x16x32_bf16 v[92:95], v[180:183], v[132:135], 0
    s_waitcnt vmcnt(5)
    v_cmp_ne_u64 vcc, v[250:251], s[96:97]
    s_add_u32 s73, s73, 262144
    s_mov_b32 s68, s73
    s_cbranch_vccnz L_SF2
L_SR2:
    v_mfma_f32_16x16x32_bf16 v[80:83], v[184:187], v[136:139], v[80:83]
    ds_read_b128 v[172:175], v252 offset:19456
    s_waitcnt lgkmcnt(7)
    v_mfma_f32_16x16x32_bf16 v[84:87], v[188:191], v[136:139], v[84:87]
    s_bfe_u32 s16, s49, 0x40000
    s_lshl_b32 s16, s16, 11
    s_add_u32 s16, s16, s68
    v_mfma_f32_16x16x32_bf16 v[88:91], v[184:187], v[140:143], v[88:91]
    ds_read_b128 v[128:131], v252 offset:20480
    s_add_u32 m0, s56, 147456
    v_mfma_f32_16x16x32_bf16 v[92:95], v[188:191], v[140:143], v[92:95]
    buffer_load_dwordx4 v252, s[44:47], s16 offen lds
    v_mfma_f32_16x16x32_bf16 v[80:83], v[192:195], v[144:147], v[80:83]
    ds_read_b128 v[132:135], v252 offset:22528
    s_waitcnt lgkmcnt(7)
    v_mfma_f32_16x16x32_bf16 v[84:87], v[196:199], v[144:147], v[84:87]
    s_bfe_u32 s17, s49, 0x40004
    s_lshl_b32 s17, s17, 11
    s_add_u32 s17, s17, s68
    v_mfma_f32_16x16x32_bf16 v[88:91], v[192:195], v[148:151], v[88:91]
    ds_read_b128 v[136:139], v252 offset:21504
    v_perm_b32 v64, v64, v67, s81
    v_mfma_f32_16x16x32_bf16 v[92:95], v[196:199], v[148:151], v[92:95]
    buffer_load_dwordx4 v252, s[44:47], s16 offen offset:1024 lds
    v_mfma_f32_16x16x32_bf16 v[80:83], v[200:203], v[152:155], v[80:83]
    ds_read_b128 v[140:143], v252 offset:23552
    s_waitcnt lgkmcnt(7)
    v_mfma_f32_16x16x32_bf16 v[84:87], v[204:207], v[152:155], v[84:87]
    s_add_u32 m0, s56, 106496
    v_perm_b32 v65, v65, v67, s82
    v_perm_b32 v66, v66, v67, s83
    v_mfma_f32_16x16x32_bf16 v[88:91], v[200:203], v[156:159], v[88:91]
    ds_read_b128 v[144:147], v252 offset:24576
    v_bfi_b32 v64, s80, v227, v64
    v_mfma_f32_16x16x32_bf16 v[92:95], v[204:207], v[156:159], v[92:95]
    buffer_load_dwordx4 v252, s[44:47], s17 offen lds
    v_mfma_f32_16x16x32_bf16 v[80:83], v[208:211], v[160:163], v[80:83]
    ds_read_b128 v[148:151], v252 offset:26624
    s_waitcnt lgkmcnt(7)
    v_mfma_f32_16x16x32_bf16 v[84:87], v[212:215], v[160:163], v[84:87]
    s_bfe_u32 s16, s49, 0x40008
    s_lshl_b32 s16, s16, 11
    s_add_u32 s16, s16, s68
    v_mfma_f32_16x16x32_bf16 v[88:91], v[208:211], v[164:167], v[88:91]
    ds_read_b128 v[152:155], v252 offset:25600
    v_mfma_f32_16x16x32_bf16 v[92:95], v[212:215], v[164:167], v[92:95]
    buffer_load_dwordx4 v252, s[44:47], s17 offen offset:1024 lds
    v_mfma_f32_16x16x32_bf16 v[80:83], v[216:219], v[168:171], v[80:83]
    ds_read_b128 v[156:159], v252 offset:27648
    s_waitcnt lgkmcnt(7)
    v_mfma_f32_16x16x32_bf16 v[84:87], v[220:223], v[168:171], v[84:87]
    s_add_u32 m0, s56, 57344
    v_mfma_f32_16x16x32_bf16 v[88:91], v[216:219], v[172:175], v[88:91]
    ds_read_b128 v[160:163], v252 offset:28672
    v_mfma_f32_16x16x32_bf16 v[92:95], v[220:223], v[172:175], v[92:95]
    buffer_load_dwordx4 v252, s[44:47], s16 offen lds
L_D2_5:
    s_cbranch_execz L_D2_6
    v_mfma_f32_16x16x32_bf16 v[80:83], a[0:3], v[128:131], v[80:83]
    ds_read_b128 v[164:167], v252 offset:30720
    s_waitcnt lgkmcnt(7)
    v_mfma_f32_16x16x32_bf16 v[84:87], a[4:7], v[128:131], v[84:87]
    s_bfe_u32 s17, s49, 0x4000c
    s_lshl_b32 s17, s17, 11
    s_add_u32 s17, s17, s68
    v_mfma_f32_16x16x32_bf16 v[88:91], a[0:3], v[132:135], v[88:91]
    ds_read_b128 v[168:171], v252 offset:29696
    v_mfma_f32_16x16x32_bf16 v[92:95], a[4:7], v[132:135], v[92:95]
    buffer_load_dwordx4 v252, s[44:47], s16 offen offset:1024 lds
    v_mfma_f32_16x16x32_bf16 v[80:83], a[8:11], v[136:139], v[80:83]
    ds_read_b128 v[172:175], v252 offset:31744
    s_waitcnt lgkmcnt(7)
    v_mfma_f32_16x16x32_bf16 v[84:87], a[12:15], v[136:139], v[84:87]
    s_add_u32 m0, s56, 8192
    v_mfma_f32_16x16x32_bf16 v[88:91], a[8:11], v[140:143], v[88:91]
    s_waitcnt vmcnt(10)
    s_barrier
    ds_read_b128 v[128:131], v252 offset:49152
    v_mfma_f32_16x16x32_bf16 v[92:95], a[12:15], v[140:143], v[92:95]
    buffer_load_dwordx4 v252, s[44:47], s17 offen lds
    v_mfma_f32_16x16x32_bf16 v[80:83], a[16:19], v[144:147], v[80:83]
    ds_read_b128 v[132:135], v252 offset:51200
    s_waitcnt lgkmcnt(7)
    v_mfma_f32_16x16x32_bf16 v[84:87], a[20:23], v[144:147], v[84:87]
    v_mfma_f32_16x16x32_bf16 v[88:91], a[16:19], v[148:151], v[88:91]
    ds_read_b128 v[136:139], v252 offset:50176
    v_mfma_f32_16x16x32_bf16 v[92:95], a[20:23], v[148:151], v[92:95]
    buffer_load_dwordx4 v252, s[44:47], s17 offen offset:1024 lds
    v_mfma_f32_16x16x32_bf16 v[80:83], a[24:27], v[152:155], v[80:83]
    ds_read_b128 v[140:143], v252 offset:52224
    s_waitcnt lgkmcnt(7)
    v_mfma_f32_16x16x32_bf16 v[84:87], a[28:31], v[152:155], v[84:87]
    buffer_store_dwordx3 v[64:66], v224, s[44:47], s88 offen offset:0 sc1
    v_mfma_f32_16x16x32_bf16 v[88:91], a[24:27], v[156:159], v[88:91]
    ds_read_b128 v[144:147], v252 offset:53248
    v_perm_b32 v68, v68, v71, s81
    v_mfma_f32_16x16x32_bf16 v[92:95], a[28:31], v[156:159], v[92:95]
    v_perm_b32 v69, v69, v71, s82
    v_perm_b32 v70, v70, v71, s83
    v_mfma_f32_16x16x32_bf16 v[80:83], a[32:35], v[160:163], v[80:83]
    ds_read_b128 v[148:151], v252 offset:55296
    s_waitcnt lgkmcnt(7)
    v_mfma_f32_16x16x32_bf16 v[84:87], a[36:39], v[160:163], v[84:87]
    v_bfi_b32 v68, s80, v227, v68
    v_mfma_f32_16x16x32_bf16 v[88:91], a[32:35], v[164:167], v[88:91]
    ds_read_b128 v[152:155], v252 offset:54272
    v_mfma_f32_16x16x32_bf16 v[92:95], a[36:39], v[164:167], v[92:95]
    buffer_store_dwordx3 v[68:70], v224, s[44:47], s88 offen offset:768 sc1
    v_mfma_f32_16x16x32_bf16 v[80:83], a[40:43], v[168:171], v[80:83]
    ds_read_b128 v[156:159], v252 offset:56320
    s_waitcnt lgkmcnt(7)
    v_mfma_f32_16x16x32_bf16 v[84:87], a[44:47], v[168:171], v[84:87]
    s_bfe_u32 s16, s49, 0x40010
    s_lshl_b32 s16, s16, 11
    s_add_u32 s16, s16, s68
    v_mfma_f32_16x16x32_bf16 v[88:91], a[40:43], v[172:175], v[88:91]
    ds_read_b128 v[160:163], v229 offset:8192
    s_add_u32 m0, s56, 0
    v_mfma_f32_16x16x32_bf16 v[92:95], a[44:47], v[172:175], v[92:95]
    buffer_load_dwordx4 v252, s[44:47], s16 offen lds
    v_mfma_f32_16x16x32_bf16 v[80:83], a[48:51], v[128:131], v[80:83]
    ds_read_b128 v[164:167], v229 offset:10240
    s_waitcnt lgkmcnt(7)
    v_mfma_f32_16x16x32_bf16 v[84:87], a[52:55], v[128:131], v[84:87]
    s_bfe_u32 s17, s49, 0x40014
    s_lshl_b32 s17, s17, 11
    s_add_u32 s17, s17, s68
    v_mfma_f32_16x16x32_bf16 v[88:91], a[48:51], v[132:135], v[88:91]
    ds_read_b128 v[168:171], v229 offset:9216
L_D2_6:
    s_cbranch_execz L_DW2
    v_perm_b32 v72, v72, v75, s81
    v_mfma_f32_16x16x32_bf16 v[92:95], a[52:55], v[132:135], v[92:95]
    buffer_load_dwordx4 v252, s[44:47], s16 offen offset:1024 lds
    v_mfma_f32_16x16x32_bf16 v[80:83], a[56:59], v[136:139], v[80:83]
    ds_read_b128 v[172:175], v229 offset:11264
    s_waitcnt lgkmcnt(7)
    v_mfma_f32_16x16x32_bf16 v[84:87], a[60:63], v[136:139], v[84:87]
    s_cmp_lg_u32 s68, s73
    s_cbranch_scc1 L_FIX2_4
L_FOK2_4:
    s_add_u32 m0, s56, 155648
    v_mfma_f32_16x16x32_bf16 v[88:91], a[56:59], v[140:143], v[88:91]
    ds_read_b128 v[128:131], v229 offset:12288
    v_mfma_f32_16x16x32_bf16 v[92:95], a[60:63], v[140:143], v[92:95]
    v_mfma_f32_16x16x32_bf16 v[80:83], a[64:67], v[144:147], v[80:83]
    ds_read_b128 v[132:135], v229 offset:14336
    s_waitcnt lgkmcnt(7)
    v_mfma_f32_16x16x32_bf16 v[84:87], a[68:71], v[144:147], v[84:87]
    v_mfma_f32_16x16x32_bf16 v[88:91], a[64:67], v[148:151], v[88:91]
    ds_read_b128 v[136:139], v229 offset:13312
    v_mfma_f32_16x16x32_bf16 v[92:95], a[68:71], v[148:151], v[92:95]
    v_mfma_f32_16x16x32_bf16 v[80:83], a[72:75], v[152:155], v[80:83]
    ds_read_b128 v[140:143], v229 offset:15360
    s_waitcnt lgkmcnt(7)
    v_mfma_f32_16x16x32_bf16 v[84:87], a[76:79], v[152:155], v[84:87]
    v_mfma_f32_16x16x32_bf16 v[88:91], a[72:75], v[156:159], v[88:91]
    s_waitcnt vmcnt(12)
    s_barrier
    ds_read_b128 v[144:147], v229 offset:0
    v_mfma_f32_16x16x32_bf16 v[92:95], a[76:79], v[156:159], v[92:95]
    v_mfma_f32_16x16x32_bf16 v[80:83], a[80:83], v[160:163], v[80:83]
    ds_read_b128 v[148:151], v229 offset:2048
    s_waitcnt lgkmcnt(7)
    v_mfma_f32_16x16x32_bf16 v[84:87], a[84:87], v[160:163], v[84:87]
    v_mfma_f32_16x16x32_bf16 v[88:91], a[80:83], v[164:167], v[88:91]
    ds_read_b128 v[152:155], v229 offset:1024
    v_mfma_f32_16x16x32_bf16 v[92:95], a[84:87], v[164:167], v[92:95]
    buffer_load_dwordx2 v[250:251], v253, s[44:47], s72 offen offset:384 sc1
    v_mfma_f32_16x16x32_bf16 v[80:83], a[88:91], v[168:171], v[80:83]
    ds_read_b128 v[156:159], v229 offset:3072
    s_waitcnt lgkmcnt(7)
    v_mfma_f32_16x16x32_bf16 v[84:87], a[92:95], v[168:171], v[84:87]
    v_perm_b32 v73, v73, v75, s82
    v_perm_b32 v74, v74, v75, s83
    v_mfma_f32_16x16x32_bf16 v[88:91], a[88:91], v[172:175], v[88:91]
    ds_read_b128 v[160:163], v229 offset:4096
    v_bfi_b32 v72, s80, v227, v72
    v_mfma_f32_16x16x32_bf16 v[92:95], a[92:95], v[172:175], v[92:95]
    v_mfma_f32_16x16x32_bf16 v[80:83], a[96:99], v[128:131], v[80:83]
    ds_read_b128 v[164:167], v229 offset:6144
    s_waitcnt lgkmcnt(7)
    v_mfma_f32_16x16x32_bf16 v[84:87], a[100:103], v[128:131], v[84:87]
    buffer_store_dwordx3 v[72:74], v224, s[44:47], s88 offen offset:1536 sc1
    v_mfma_f32_16x16x32_bf16 v[88:91], a[96:99], v[132:135], v[88:91]
    ds_read_b128 v[168:171], v229 offset:5120
    v_perm_b32 v76, v76, v79, s81
    v_mfma_f32_16x16x32_bf16 v[92:95], a[100:103], v[132:135], v[92:95]
    v_perm_b32 v77, v77, v79, s82
    v_perm_b32 v78, v78, v79, s83
    v_mfma_f32_16x16x32_bf16 v[80:83], a[104:107], v[136:139], v[80:83]
    ds_read_b128 v[172:175], v229 offset:7168
    s_waitcnt lgkmcnt(7)
    v_mfma_f32_16x16x32_bf16 v[84:87], a[108:111], v[136:139], v[84:87]
    buffer_load_dwordx4 v252, s[44:47], s17 offen lds
    v_mfma_f32_16x16x32_bf16 v[88:91], a[104:107], v[140:143], v[88:91]
    ds_read_b128 v[128:131], v228 offset:32768
    s_bfe_u32 s16, s49, 0x40018
    v_mfma_f32_16x16x32_bf16 v[92:95], a[108:111], v[140:143], v[92:95]
    s_lshl_b32 s16, s16, 11
    s_add_u32 s16, s16, s68
    v_bfi_b32 v76, s80, v227, v76
L_D2_7:
    s_cbranch_execz L_DW2
    v_mfma_f32_16x16x32_bf16 v[80:83], a[112:115], v[144:147], v[80:83]
    ds_read_b128 v[132:135], v228 offset:34816
    s_waitcnt lgkmcnt(7)
    v_mfma_f32_16x16x32_bf16 v[84:87], a[116:119], v[144:147], v[84:87]
    buffer_store_dwordx3 v[76:78], v224, s[44:47], s88 offen offset:2304 sc1
    v_mfma_f32_16x16x32_bf16 v[88:91], a[112:115], v[148:151], v[88:91]
    ds_read_b128 v[136:139], v228 offset:33792
    v_mfma_f32_16x16x32_bf16 v[92:95], a[116:119], v[148:151], v[92:95]
    v_mfma_f32_16x16x32_bf16 v[80:83], a[120:123], v[152:155], v[80:83]
    ds_read_b128 v[140:143], v228 offset:35840
    s_waitcnt lgkmcnt(7)
    v_mfma_f32_16x16x32_bf16 v[84:87], a[124:127], v[152:155], v[84:87]
    buffer_load_dwordx4 v252, s[44:47], s17 offen offset:1024 lds
    v_mfma_f32_16x16x32_bf16 v[88:91], a[120:123], v[156:159], v[88:91]
    ds_read_b128 v[144:147], v228 offset:36864
    s_add_u32 m0, s56, 49152
    v_mfma_f32_16x16x32_bf16 v[92:95], a[124:127], v[156:159], v[92:95]
    v_mfma_f32_16x16x32_bf16 v[80:83], v[0:3], v[160:163], v[80:83]
    ds_read_b128 v[148:151], v228 offset:38912
    s_waitcnt lgkmcnt(7)
    v_mfma_f32_16x16x32_bf16 v[84:87], v[4:7], v[160:163], v[84:87]
    v_mfma_f32_16x16x32_bf16 v[88:91], v[0:3], v[164:167], v[88:91]
    ds_read_b128 v[152:155], v228 offset:37888
    v_mfma_f32_16x16x32_bf16 v[92:95], v[4:7], v[164:167], v[92:95]
    buffer_load_dwordx4 v252, s[44:47], s16 offen lds
    v_mfma_f32_16x16x32_bf16 v[80:83], v[8:11], v[168:171], v[80:83]
    ds_read_b128 v[156:159], v228 offset:39936
    s_waitcnt lgkmcnt(7)
    v_mfma_f32_16x16x32_bf16 v[84:87], v[12:15], v[168:171], v[84:87]
    s_cmp_lg_u32 s68, s73
    s_cbranch_scc1 L_FIX2
L_FOK2:
    v_mfma_f32_16x16x32_bf16 v[88:91], v[8:11], v[172:175], v[88:91]
    s_waitcnt vmcnt(14)
    s_barrier
    ds_read_b128 v[160:163], v229 offset:16384
    v_mfma_f32_16x16x32_bf16 v[92:95], v[12:15], v[172:175], v[92:95]
    buffer_load_dwordx4 v252, s[44:47], s16 offen offset:1024 lds
    v_mfma_f32_16x16x32_bf16 v[80:83], v[16:19], v[128:131], v[80:83]
    ds_read_b128 v[164:167], v229 offset:18432
    s_waitcnt lgkmcnt(7)
    v_mfma_f32_16x16x32_bf16 v[84:87], v[20:23], v[128:131], v[84:87]
    v_mfma_f32_16x16x32_bf16 v[88:91], v[16:19], v[132:135], v[88:91]
    ds_read_b128 v[168:171], v229 offset:17408
    v_mfma_f32_16x16x32_bf16 v[92:95], v[20:23], v[132:135], v[92:95]
    v_mfma_f32_16x16x32_bf16 v[80:83], v[24:27], v[136:139], v[80:83]
    ds_read_b128 v[172:175], v229 offset:19456
    s_waitcnt lgkmcnt(7)
    v_mfma_f32_16x16x32_bf16 v[84:87], v[28:31], v[136:139], v[84:87]
    v_mfma_f32_16x16x32_bf16 v[88:91], v[24:27], v[140:143], v[88:91]
    ds_read_b128 v[128:131], v229 offset:20480
    v_mfma_f32_16x16x32_bf16 v[92:95], v[28:31], v[140:143], v[92:95]
    v_mfma_f32_16x16x32_bf16 v[80:83], v[32:35], v[144:147], v[80:83]
    ds_read_b128 v[132:135], v229 offset:22528
    s_waitcnt lgkmcnt(7)
    v_mfma_f32_16x16x32_bf16 v[84:87], v[36:39], v[144:147], v[84:87]
    v_mfma_f32_16x16x32_bf16 v[88:91], v[32:35], v[148:151], v[88:91]
    ds_read_b128 v[136:139], v229 offset:21504
    v_mfma_f32_16x16x32_bf16 v[92:95], v[36:39], v[148:151], v[92:95]
    v_mfma_f32_16x16x32_bf16 v[80:83], v[40:43], v[152:155], v[80:83]
    ds_read_b128 v[140:143], v229 offset:23552
    s_waitcnt lgkmcnt(7)
    v_mfma_f32_16x16x32_bf16 v[84:87], v[44:47], v[152:155], v[84:87]
    v_mfma_f32_16x16x32_bf16 v[88:91], v[40:43], v[156:159], v[88:91]
    ds_read_b128 v[144:147], v228 offset:40960
    v_mfma_f32_16x16x32_bf16 v[92:95], v[44:47], v[156:159], v[92:95]
    v_mfma_f32_16x16x32_bf16 v[64:67], v[176:179], v[160:163], 0
    ds_read_b128 v[148:151], v228 offset:43008
    s_waitcnt lgkmcnt(7)
    v_mfma_f32_16x16x32_bf16 v[68:71], v[180:183], v[160:163], 0
    v_mfma_f32_16x16x32_bf16 v[72:75], v[176:179], v[164:167], 0
L_D2_8:
    s_cbranch_execz L_D2_9
    ds_read_b128 v[152:155], v228 offset:41984
    v_mfma_f32_16x16x32_bf16 v[76:79], v[180:183], v[164:167], 0
    s_waitcnt vmcnt(6)
    v_cmp_ne_u64 vcc, v[250:251], s[96:97]
    s_add_u32 s73, s73, 262144
    s_mov_b32 s68, s73
    s_cbranch_vccnz L_SF3
L_SR3:
    v_mfma_f32_16x16x32_bf16 v[64:67], v[184:187], v[168:171], v[64:67]
    ds_read_b128 v[156:159], v228 offset:44032
    s_waitcnt lgkmcnt(7)
    v_mfma_f32_16x16x32_bf16 v[68:71], v[188:191], v[168:171], v[68:71]
    s_bfe_u32 s17, s49, 0x40000
    s_lshl_b32 s17, s17, 11
    s_add_u32 s17, s17, s68
    v_mfma_f32_16x16x32_bf16 v[72:75], v[184:187], v[172:175], v[72:75]
    ds_read_b128 v[160:163], v228 offset:45056
    s_add_u32 m0, s56, 32768
    v_mfma_f32_16x16x32_bf16 v[76:79], v[188:191], v[172:175], v[76:79]
    buffer_load_dwordx4 v252, s[44:47], s17 offen lds
    v_mfma_f32_16x16x32_bf16 v[64:67], v[192:195], v[128:131], v[64:67]
    ds_read_b128 v[164:167], v228 offset:47104
    s_waitcnt lgkmcnt(7)
    v_mfma_f32_16x16x32_bf16 v[68:71], v[196:199], v[128:131], v[68:71]
    s_bfe_u32 s16, s49, 0x40004
    s_lshl_b32 s16, s16, 11
    s_add_u32 s16, s16, s68
    v_mfma_f32_16x16x32_bf16 v[72:75], v[192:195], v[132:135], v[72:75]
    ds_read_b128 v[168:171], v228 offset:46080
    v_perm_b32 v80, v80, v83, s81
    v_mfma_f32_16x16x32_bf16 v[76:79], v[196:199], v[132:135], v[76:79]
    buffer_load_dwordx4 v252, s[44:47], s17 offen offset:1024 lds
    v_mfma_f32_16x16x32_bf16 v[64:67], v[200:203], v[136:139], v[64:67]
    ds_read_b128 v[172:175], v228 offset:48128
    s_waitcnt lgkmcnt(7)
    v_mfma_f32_16x16x32_bf16 v[68:71], v[204:207], v[136:139], v[68:71]
    s_add_u32 m0, s56, 40960
    v_perm_b32 v81, v81, v83, s82
    v_perm_b32 v82, v82, v83, s83
    v_mfma_f32_16x16x32_bf16 v[72:75], v[200:203], v[140:143], v[72:75]
    s_barrier
    ds_read_b128 v[128:131], v252 offset:57344
    v_bfi_b32 v80, s80, v227, v80
    v_mfma_f32_16x16x32_bf16 v[76:79], v[204:207], v[140:143], v[76:79]
    buffer_load_dwordx4 v252, s[44:47], s16 offen lds
    v_mfma_f32_16x16x32_bf16 v[64:67], v[208:211], v[144:147], v[64:67]
    ds_read_b128 v[132:135], v252 offset:59392
    s_waitcnt lgkmcnt(7)
    v_mfma_f32_16x16x32_bf16 v[68:71], v[212:215], v[144:147], v[68:71]
    s_bfe_u32 s17, s49, 0x40008
    s_lshl_b32 s17, s17, 11
    s_add_u32 s17, s17, s68
    v_mfma_f32_16x16x32_bf16 v[72:75], v[208:211], v[148:151], v[72:75]
    ds_read_b128 v[136:139], v252 offset:58368
    v_mfma_f32_16x16x32_bf16 v[76:79], v[212:215], v[148:151], v[76:79]
    buffer_load_dwordx4 v252, s[44:47], s16 offen offset:1024 lds
    v_mfma_f32_16x16x32_bf16 v[64:67], v[216:219], v[152:155], v[64:67]
    ds_read_b128 v[140:143], v252 offset:60416
    s_waitcnt lgkmcnt(7)
    v_mfma_f32_16x16x32_bf16 v[68:71], v[220:223], v[152:155], v[68:71]
    s_add_u32 m0, s56, 98304
    v_mfma_f32_16x16x32_bf16 v[72:75], v[216:219], v[156:159], v[72:75]
    ds_read_b128 v[144:147], v252 offset:61440
    v_mfma_f32_16x16x32_bf16 v[76:79], v[220:223], v[156:159], v[76:79]
    buffer_load_dwordx4 v252, s[44:47], s17 offen lds
    v_mfma_f32_16x16x32_bf16 v[64:67], a[0:3], v[160:163], v[64:67]
    ds_read_b128 v[148:151], v252 offset:63488
    s_waitcnt lgkmcnt(7)
    v_mfma_f32_16x16x32_bf16 v[68:71], a[4:7], v[160:163], v[68:71]
    v_mfma_f32_16x16x32_bf16 v[72:75], a[0:3], v[164:167], v[72:75]
    ds_read_b128 v[152:155], v252 offset:62464
    v_mfma_f32_16x16x32_bf16 v[76:79], a[4:7], v[164:167], v[76:79]
    buffer_load_dwordx4 v252, s[44:47], s17 offen offset:1024 lds
L_D2_9:
    s_cbranch_execz L_DW2
    v_mfma_f32_16x16x32_bf16 v[64:67], a[8:11], v[168:171], v[64:67]
    ds_read_b128 v[156:159], v252 offset:64512
    s_waitcnt lgkmcnt(7)
    v_mfma_f32_16x16x32_bf16 v[68:71], a[12:15], v[168:171], v[68:71]
    s_bfe_u32 s16, s49, 0x4000c
    s_lshl_b32 s16, s16, 11
    s_add_u32 s16, s16, s68
    v_mfma_f32_16x16x32_bf16 v[72:75], a[8:11], v[172:175], v[72:75]
    ds_read_b128 v[160:163], v252 offset:8192
    s_add_u32 m0, s56, 147456
    v_mfma_f32_16x16x32_bf16 v[76:79], a[12:15], v[172:175], v[76:79]
    buffer_load_dwordx4 v252, s[44:47], s16 offen lds
    v_mfma_f32_16x16x32_bf16 v[64:67], a[16:19], v[128:131], v[64:67]
    ds_read_b128 v[164:167], v252 offset:10240
    s_waitcnt lgkmcnt(7)
    v_mfma_f32_16x16x32_bf16 v[68:71], a[20:23], v[128:131], v[68:71]
    s_bfe_u32 s17, s49, 0x40010
    s_lshl_b32 s17, s17, 11
    s_add_u32 s17, s17, s68
    v_mfma_f32_16x16x32_bf16 v[72:75], a[16:19], v[132:135], v[72:75]
    ds_read_b128 v[168:171], v252 offset:9216
    v_mfma_f32_16x16x32_bf16 v[76:79], a[20:23], v[132:135], v[76:79]
    buffer_load_dwordx4 v252, s[44:47], s16 offen offset:1024 lds
    v_mfma_f32_16x16x32_bf16 v[64:67], a[24:27], v[136:139], v[64:67]
    ds_read_b128 v[172:175], v252 offset:11264
    s_waitcnt lgkmcnt(7)
    v_mfma_f32_16x16x32_bf16 v[68:71], a[28:31], v[136:139], v[68:71]
    s_add_u32 m0, s56, 81920
    v_mfma_f32_16x16x32_bf16 v[72:75], a[24:27], v[140:143], v[72:75]
    ds_read_b128 v[128:131], v252 offset:12288
    v_mfma_f32_16x16x32_bf16 v[76:79], a[28:31], v[140:143], v[76:79]
    buffer_load_dwordx4 v252, s[44:47], s17 offen lds
    v_mfma_f32_16x16x32_bf16 v[64:67], a[32:35], v[144:147], v[64:67]
    ds_read_b128 v[132:135], v252 offset:14336
    s_waitcnt lgkmcnt(7)
    v_mfma_f32_16x16x32_bf16 v[68:71], a[36:39], v[144:147], v[68:71]
    v_mfma_f32_16x16x32_bf16 v[72:75], a[32:35], v[148:151], v[72:75]
    ds_read_b128 v[136:139], v252 offset:13312
    v_mfma_f32_16x16x32_bf16 v[76:79], a[36:39], v[148:151], v[76:79]
    buffer_load_dwordx4 v252, s[44:47], s17 offen offset:1024 lds
    v_mfma_f32_16x16x32_bf16 v[64:67], a[40:43], v[152:155], v[64:67]
    ds_read_b128 v[140:143], v252 offset:15360
    s_waitcnt lgkmcnt(7)
    v_mfma_f32_16x16x32_bf16 v[68:71], a[44:47], v[152:155], v[68:71]
    buffer_store_dwordx3 v[80:82], v224, s[44:47], s89 offen offset:0 sc1
    v_mfma_f32_16x16x32_bf16 v[72:75], a[40:43], v[156:159], v[72:75]
    s_waitcnt vmcnt(13)
    s_barrier
    ds_read_b128 v[144:147], v252 offset:0
    v_perm_b32 v84, v84, v87, s81
    v_mfma_f32_16x16x32_bf16 v[76:79], a[44:47], v[156:159], v[76:79]
    v_perm_b32 v85, v85, v87, s82
    v_perm_b32 v86, v86, v87, s83
    v_mfma_f32_16x16x32_bf16 v[64:67], a[48:51], v[160:163], v[64:67]
    ds_read_b128 v[148:151], v252 offset:2048
    s_waitcnt lgkmcnt(7)
    v_mfma_f32_16x16x32_bf16 v[68:71], a[52:55], v[160:163], v[68:71]
    v_bfi_b32 v84, s80, v227, v84
    v_mfma_f32_16x16x32_bf16 v[72:75], a[48:51], v[164:167], v[72:75]
    ds_read_b128 v[152:155], v252 offset:1024
    v_mfma_f32_16x16x32_bf16 v[76:79], a[52:55], v[164:167], v[76:79]
    buffer_store_dwordx3 v[84:86], v224, s[44:47], s89 offen offset:768 sc1
    v_mfma_f32_16x16x32_bf16 v[64:67], a[56:59], v[168:171], v[64:67]
    ds_read_b128 v[156:159], v252 offset:3072
    s_waitcnt lgkmcnt(7)
    v_mfma_f32_16x16x32_bf16 v[68:71], a[60:63], v[168:171], v[68:71]
    s_cmp_lg_u32 s68, s73
    s_cbranch_scc1 L_FIX3_6
L_FOK3_6:
    v_perm_b32 v88, v88, v91, s81
    v_mfma_f32_16x16x32_bf16 v[72:75], a[56:59], v[172:175], v[72:75]
    ds_read_b128 v[160:163], v252 offset:4096
L_D2_10:
    s_cbranch_execz L_DW2
    v_perm_b32 v89, v89, v91, s82
    v_mfma_f32_16x16x32_bf16 v[76:79], a[60:63], v[172:175], v[76:79]
    v_perm_b32 v90, v90, v91, s83
    v_bfi_b32 v88, s80, v227, v88
    v_mfma_f32_16x16x32_bf16 v[64:67], a[64:67], v[128:131], v[64:67]
    ds_read_b128 v[164:167], v252 offset:6144
    s_waitcnt lgkmcnt(7)
    v_mfma_f32_16x16x32_bf16 v[68:71], a[68:71], v[128:131], v[68:71]
    v_mfma_f32_16x16x32_bf16 v[72:75], a[64:67], v[132:135], v[72:75]
    ds_read_b128 v[168:171], v252 offset:5120
    v_mfma_f32_16x16x32_bf16 v[76:79], a[68:71], v[132:135], v[76:79]
    v_mfma_f32_16x16x32_bf16 v[64:67], a[72:75], v[136:139], v[64:67]
    ds_read_b128 v[172:175], v252 offset:7168
    s_waitcnt lgkmcnt(7)
    v_mfma_f32_16x16x32_bf16 v[68:71], a[76:79], v[136:139], v[68:71]
    s_bfe_u32 s16, s49, 0x40014
    s_lshl_b32 s16, s16, 11
    s_add_u32 s16, s16, s68
    v_mfma_f32_16x16x32_bf16 v[72:75], a[72:75], v[140:143], v[72:75]
    ds_read_b128 v[128:131], v229 offset:24576
    s_add_u32 m0, s56, 90112
    v_mfma_f32_16x16x32_bf16 v[76:79], a[76:79], v[140:143], v[76:79]
    v_mfma_f32_16x16x32_bf16 v[64:67], a[80:83], v[144:147], v[64:67]
    ds_read_b128 v[132:135], v229 offset:26624
    s_waitcnt lgkmcnt(7)
    v_mfma_f32_16x16x32_bf16 v[68:71], a[84:87], v[144:147], v[68:71]
    v_mfma_f32_16x16x32_bf16 v[72:75], a[80:83], v[148:151], v[72:75]
    ds_read_b128 v[136:139], v229 offset:25600
    v_mfma_f32_16x16x32_bf16 v[76:79], a[84:87], v[148:151], v[76:79]
    buffer_load_dwordx4 v252, s[44:47], s16 offen lds
    v_mfma_f32_16x16x32_bf16 v[64:67], a[88:91], v[152:155], v[64:67]
    ds_read_b128 v[140:143], v229 offset:27648
    s_waitcnt lgkmcnt(7)
    v_mfma_f32_16x16x32_bf16 v[68:71], a[92:95], v[152:155], v[68:71]
    s_bfe_u32 s17, s49, 0x40018
    s_lshl_b32 s17, s17, 11
    s_add_u32 s17, s17, s68
    v_mfma_f32_16x16x32_bf16 v[72:75], a[88:91], v[156:159], v[72:75]
    ds_read_b128 v[144:147], v229 offset:28672
    v_mfma_f32_16x16x32_bf16 v[76:79], a[92:95], v[156:159], v[76:79]
    v_mfma_f32_16x16x32_bf16 v[64:67], a[96:99], v[160:163], v[64:67]
    ds_read_b128 v[148:151], v229 offset:30720
    s_waitcnt lgkmcnt(7)
    v_mfma_f32_16x16x32_bf16 v[68:71], a[100:103], v[160:163], v[68:71]
    buffer_store_dwordx3 v[88:90], v224, s[44:47], s89 offen offset:1536 sc1
    v_mfma_f32_16x16x32_bf16 v[72:75], a[96:99], v[164:167], v[72:75]
    ds_read_b128 v[152:155], v229 offset:29696
    v_perm_b32 v92, v92, v95, s81
    v_mfma_f32_16x16x32_bf16 v[76:79], a[100:103], v[164:167], v[76:79]
    v_perm_b32 v93, v93, v95, s82
    v_perm_b32 v94, v94, v95, s83
    v_mfma_f32_16x16x32_bf16 v[64:67], a[104:107], v[168:171], v[64:67]
    ds_read_b128 v[156:159], v229 offset:31744
    s_waitcnt lgkmcnt(7)
    v_mfma_f32_16x16x32_bf16 v[68:71], a[108:111], v[168:171], v[68:71]
    s_cmp_lg_u32 s68, s73
    s_cbranch_scc1 L_FIX3
L_FOK3:
    v_bfi_b32 v92, s80, v227, v92
    v_mfma_f32_16x16x32_bf16 v[72:75], a[104:107], v[172:175], v[72:75]
    s_waitcnt vmcnt(12)
    s_barrier
    ds_read_b128 v[160:163], v252 offset:49152
    v_mfma_f32_16x16x32_bf16 v[76:79], a[108:111], v[172:175], v[76:79]
    buffer_store_dwordx3 v[92:94], v224, s[44:47], s89 offen offset:2304 sc1
    v_mfma_f32_16x16x32_bf16 v[64:67], a[112:115], v[128:131], v[64:67]
    ds_read_b128 v[164:167], v252 offset:51200
    s_waitcnt lgkmcnt(7)
    v_mfma_f32_16x16x32_bf16 v[68:71], a[116:119], v[128:131], v[68:71]
    buffer_load_dwordx4 v252, s[44:47], s16 offen offset:1024 lds
    v_mfma_f32_16x16x32_bf16 v[72:75], a[112:115], v[132:135], v[72:75]
    ds_read_b128 v[168:171], v252 offset:50176
L_D2_11:
    s_cbranch_execz L_DW2
    s_add_u32 m0, s56, 106496
    v_mfma_f32_16x16x32_bf16 v[76:79], a[116:119], v[132:135], v[76:79]
    v_mfma_f32_16x16x32_bf16 v[64:67], a[120:123], v[136:139], v[64:67]
    ds_read_b128 v[172:175], v252 offset:52224
    s_waitcnt lgkmcnt(7)
    v_mfma_f32_16x16x32_bf16 v[68:71], a[124:127], v[136:139], v[68:71]
    buffer_load_dwordx4 v252, s[44:47], s17 offen lds
    v_mfma_f32_16x16x32_bf16 v[72:75], a[120:123], v[140:143], v[72:75]
    ds_read_b128 v[128:131], v252 offset:53248
    s_add_u32 s63, s91, 0
    v_mfma_f32_16x16x32_bf16 v[76:79], a[124:127], v[140:143], v[76:79]
    v_mfma_f32_16x16x32_bf16 v[64:67], v[0:3], v[144:147], v[64:67]
    ds_read_b128 v[132:135], v252 offset:55296
    s_waitcnt lgkmcnt(7)
    v_mfma_f32_16x16x32_bf16 v[68:71], v[4:7], v[144:147], v[68:71]
    v_mfma_f32_16x16x32_bf16 v[72:75], v[0:3], v[148:151], v[72:75]
    ds_read_b128 v[136:139], v252 offset:54272
    v_mfma_f32_16x16x32_bf16 v[76:79], v[4:7], v[148:151], v[76:79]
    buffer_load_dwordx3 v[96:98], v224, s[44:47], s63 offen offset:0 sc1
    v_mfma_f32_16x16x32_bf16 v[64:67], v[8:11], v[152:155], v[64:67]
    ds_read_b128 v[140:143], v252 offset:56320
    s_waitcnt lgkmcnt(7)
    v_mfma_f32_16x16x32_bf16 v[68:71], v[12:15], v[152:155], v[68:71]
    v_mfma_f32_16x16x32_bf16 v[72:75], v[8:11], v[156:159], v[72:75]
    ds_read_b128 v[144:147], v252 offset:32768
    v_mfma_f32_16x16x32_bf16 v[76:79], v[12:15], v[156:159], v[76:79]
    buffer_load_dwordx3 v[100:102], v224, s[44:47], s63 offen offset:768 sc1
    v_mfma_f32_16x16x32_bf16 v[64:67], v[16:19], v[160:163], v[64:67]
    ds_read_b128 v[148:151], v252 offset:34816
    s_waitcnt lgkmcnt(7)
    v_mfma_f32_16x16x32_bf16 v[68:71], v[20:23], v[160:163], v[68:71]
    v_mfma_f32_16x16x32_bf16 v[72:75], v[16:19], v[164:167], v[72:75]
    ds_read_b128 v[152:155], v252 offset:33792
    v_mfma_f32_16x16x32_bf16 v[76:79], v[20:23], v[164:167], v[76:79]
    buffer_load_dwordx3 v[104:106], v224, s[44:47], s63 offen offset:1536 sc1
    v_mfma_f32_16x16x32_bf16 v[64:67], v[24:27], v[168:171], v[64:67]
    ds_read_b128 v[156:159], v252 offset:35840
    s_waitcnt lgkmcnt(7)
    v_mfma_f32_16x16x32_bf16 v[68:71], v[28:31], v[168:171], v[68:71]
    v_mfma_f32_16x16x32_bf16 v[72:75], v[24:27], v[172:175], v[72:75]
    ds_read_b128 v[160:163], v252 offset:36864
    v_mfma_f32_16x16x32_bf16 v[76:79], v[28:31], v[172:175], v[76:79]
    buffer_load_dwordx3 v[108:110], v224, s[44:47], s63 offen offset:2304 sc1
    v_mfma_f32_16x16x32_bf16 v[64:67], v[32:35], v[128:131], v[64:67]
    ds_read_b128 v[164:167], v252 offset:38912
    s_waitcnt lgkmcnt(7)
    v_mfma_f32_16x16x32_bf16 v[68:71], v[36:39], v[128:131], v[68:71]
    v_mfma_f32_16x16x32_bf16 v[72:75], v[32:35], v[132:135], v[72:75]
    ds_read_b128 v[168:171], v252 offset:37888
    v_mfma_f32_16x16x32_bf16 v[76:79], v[36:39], v[132:135], v[76:79]
    buffer_load_dwordx4 v252, s[44:47], s17 offen offset:1024 lds
    v_mfma_f32_16x16x32_bf16 v[64:67], v[40:43], v[136:139], v[64:67]
    ds_read_b128 v[172:175], v252 offset:39936
    s_waitcnt lgkmcnt(7)
    v_mfma_f32_16x16x32_bf16 v[68:71], v[44:47], v[136:139], v[68:71]
    v_mfma_f32_16x16x32_bf16 v[72:75], v[40:43], v[140:143], v[72:75]
    s_waitcnt vmcnt(16)
    s_barrier
    ds_read_b128 v[128:131], v252 offset:40960
    v_mfma_f32_16x16x32_bf16 v[76:79], v[44:47], v[140:143], v[76:79]
    v_mfma_f32_16x16x32_bf16 v[80:83], v[176:179], v[144:147], 0
    ds_read_b128 v[132:135], v252 offset:43008
    s_waitcnt lgkmcnt(7)
    v_mfma_f32_16x16x32_bf16 v[84:87], v[180:183], v[144:147], 0
    v_mfma_f32_16x16x32_bf16 v[88:91], v[176:179], v[148:151], 0
    ds_read_b128 v[136:139], v252 offset:41984
    v_perm_b32 v64, v64, v67, s81
    v_mfma_f32_16x16x32_bf16 v[92:95], v[180:183], v[148:151], 0
    v_perm_b32 v65, v65, v67, s82
L_ST6:
    s_cbranch_execz L_WALKED
L_D1_28:
    s_cbranch_execz L_DW1
L_D2_12:
    s_cbranch_execz L_D2_13
    v_perm_b32 v66, v66, v67, s83
    v_mfma_f32_16x16x32_bf16 v[80:83], v[184:187], v[152:155], v[80:83]
    ds_read_b128 v[140:143], v252 offset:44032
    s_waitcnt lgkmcnt(7)
    v_mfma_f32_16x16x32_bf16 v[84:87], v[188:191], v[152:155], v[84:87]
    v_bfi_b32 v64, s80, v227, v64
    v_mfma_f32_16x16x32_bf16 v[88:91], v[184:187], v[156:159], v[88:91]
    ds_read_b128 v[144:147], v252 offset:45056
    v_mfma_f32_16x16x32_bf16 v[92:95], v[188:191], v[156:159], v[92:95]
    buffer_store_dwordx3 v[64:66], v224, s[44:47], s90 offen offset:0 sc1
    v_mfma_f32_16x16x32_bf16 v[80:83], v[192:195], v[160:163], v[80:83]
    ds_read_b128 v[148:151], v252 offset:47104
    s_waitcnt lgkmcnt(7)
    v_mfma_f32_16x16x32_bf16 v[84:87], v[196:199], v[160:163], v[84:87]
    v_perm_b32 v68, v68, v71, s81
    v_perm_b32 v69, v69, v71, s82
    v_mfma_f32_16x16x32_bf16 v[88:91], v[192:195], v[164:167], v[88:91]
    ds_read_b128 v[152:155], v252 offset:46080
    v_perm_b32 v70, v70, v71, s83
    v_mfma_f32_16x16x32_bf16 v[92:95], v[196:199], v[164:167], v[92:95]
    v_bfi_b32 v68, s80, v227, v68
    v_mfma_f32_16x16x32_bf16 v[80:83], v[200:203], v[168:171], v[80:83]
    ds_read_b128 v[156:159], v252 offset:48128
    s_waitcnt lgkmcnt(7)
    v_mfma_f32_16x16x32_bf16 v[84:87], v[204:207], v[168:171], v[84:87]
    buffer_store_dwordx3 v[68:70], v224, s[44:47], s90 offen offset:768 sc1
    v_mfma_f32_16x16x32_bf16 v[88:91], v[200:203], v[172:175], v[88:91]
    ds_read_b128 v[160:163], v228 offset:32768
    v_perm_b32 v72, v72, v75, s81
    v_mfma_f32_16x16x32_bf16 v[92:95], v[204:207], v[172:175], v[92:95]
    v_perm_b32 v73, v73, v75, s82
    v_perm_b32 v74, v74, v75, s83
    v_mfma_f32_16x16x32_bf16 v[80:83], v[208:211], v[128:131], v[80:83]
    ds_read_b128 v[164:167], v228 offset:34816
    s_waitcnt lgkmcnt(7)
    v_mfma_f32_16x16x32_bf16 v[84:87], v[212:215], v[128:131], v[84:87]
    v_bfi_b32 v72, s80, v227, v72
    v_mfma_f32_16x16x32_bf16 v[88:91], v[208:211], v[132:135], v[88:91]
    ds_read_b128 v[168:171], v228 offset:33792
    v_mfma_f32_16x16x32_bf16 v[92:95], v[212:215], v[132:135], v[92:95]
    buffer_store_dwordx3 v[72:74], v224, s[44:47], s90 offen offset:1536 sc1
    v_mfma_f32_16x16x32_bf16 v[80:83], v[216:219], v[136:139], v[80:83]
    ds_read_b128 v[172:175], v228 offset:35840
    s_waitcnt lgkmcnt(7)
    v_mfma_f32_16x16x32_bf16 v[84:87], v[220:223], v[136:139], v[84:87]
    v_perm_b32 v76, v76, v79, s81
    v_perm_b32 v77, v77, v79, s82
    v_mfma_f32_16x16x32_bf16 v[88:91], v[216:219], v[140:143], v[88:91]
    ds_read_b128 v[128:131], v228 offset:36864
    v_perm_b32 v78, v78, v79, s83
    v_mfma_f32_16x16x32_bf16 v[92:95], v[220:223], v[140:143], v[92:95]
    v_bfi_b32 v76, s80, v227, v76
    v_mfma_f32_16x16x32_bf16 v[80:83], a[0:3], v[144:147], v[80:83]
    ds_read_b128 v[132:135], v228 offset:38912
    s_waitcnt lgkmcnt(7)
    v_mfma_f32_16x16x32_bf16 v[84:87], a[4:7], v[144:147], v[84:87]
    buffer_store_dwordx3 v[76:78], v224, s[44:47], s90 offen offset:2304 sc1
    v_mfma_f32_16x16x32_bf16 v[88:91], a[0:3], v[148:151], v[88:91]
    ds_read_b128 v[136:139], v228 offset:37888
    s_add_u32 s63, s91, 16384
    v_mfma_f32_16x16x32_bf16 v[92:95], a[4:7], v[148:151], v[92:95]
    buffer_load_dwordx3 v[112:114], v224, s[44:47], s63 offen offset:0 sc1
    v_mfma_f32_16x16x32_bf16 v[80:83], a[8:11], v[152:155], v[80:83]
    ds_read_b128 v[140:143], v228 offset:39936
    s_waitcnt lgkmcnt(7)
    v_mfma_f32_16x16x32_bf16 v[84:87], a[12:15], v[152:155], v[84:87]
L_D2_13:
    s_cbranch_execz L_DW2
    buffer_load_dwordx3 v[116:118], v224, s[44:47], s63 offen offset:768 sc1
    v_mfma_f32_16x16x32_bf16 v[88:91], a[8:11], v[156:159], v[88:91]
    s_waitcnt vmcnt(18)
    s_barrier
    ds_read_b128 v[144:147], v229 offset:16384
    v_mfma_f32_16x16x32_bf16 v[92:95], a[12:15], v[156:159], v[92:95]
    buffer_load_dwordx3 v[120:122], v224, s[44:47], s63 offen offset:1536 sc1
    v_mfma_f32_16x16x32_bf16 v[80:83], a[16:19], v[160:163], v[80:83]
    ds_read_b128 v[148:151], v229 offset:18432
    s_waitcnt lgkmcnt(7)
    v_mfma_f32_16x16x32_bf16 v[84:87], a[20:23], v[160:163], v[84:87]
    v_mfma_f32_16x16x32_bf16 v[88:91], a[16:19], v[164:167], v[88:91]
    ds_read_b128 v[152:155], v229 offset:17408
    v_mfma_f32_16x16x32_bf16 v[92:95], a[20:23], v[164:167], v[92:95]
    v_mfma_f32_16x16x32_bf16 v[80:83], a[24:27], v[168:171], v[80:83]
    ds_read_b128 v[156:159], v229 offset:19456
    s_waitcnt lgkmcnt(7)
    v_mfma_f32_16x16x32_bf16 v[84:87], a[28:31], v[168:171], v[84:87]
    v_mfma_f32_16x16x32_bf16 v[88:91], a[24:27], v[172:175], v[88:91]
    ds_read_b128 v[160:163], v229 offset:20480
    v_mfma_f32_16x16x32_bf16 v[92:95], a[28:31], v[172:175], v[92:95]
    v_mfma_f32_16x16x32_bf16 v[80:83], a[32:35], v[128:131], v[80:83]
    ds_read_b128 v[164:167], v229 offset:22528
    s_waitcnt lgkmcnt(7)
    v_mfma_f32_16x16x32_bf16 v[84:87], a[36:39], v[128:131], v[84:87]
    v_mfma_f32_16x16x32_bf16 v[88:91], a[32:35], v[132:135], v[88:91]
    ds_read_b128 v[168:171], v229 offset:21504
    v_mfma_f32_16x16x32_bf16 v[92:95], a[36:39], v[132:135], v[92:95]
    v_mfma_f32_16x16x32_bf16 v[80:83], a[40:43], v[136:139], v[80:83]
    ds_read_b128 v[172:175], v229 offset:23552
    s_waitcnt lgkmcnt(7)
    v_mfma_f32_16x16x32_bf16 v[84:87], a[44:47], v[136:139], v[84:87]
    v_mfma_f32_16x16x32_bf16 v[88:91], a[40:43], v[140:143], v[88:91]
    ds_read_b128 v[128:131], v228 offset:16384
    v_mfma_f32_16x16x32_bf16 v[92:95], a[44:47], v[140:143], v[92:95]
    v_mfma_f32_16x16x32_bf16 v[80:83], a[48:51], v[144:147], v[80:83]
    ds_read_b128 v[132:135], v228 offset:18432
    s_waitcnt lgkmcnt(7)
    v_mfma_f32_16x16x32_bf16 v[84:87], a[52:55], v[144:147], v[84:87]
    v_mfma_f32_16x16x32_bf16 v[88:91], a[48:51], v[148:151], v[88:91]
    ds_read_b128 v[136:139], v228 offset:17408
    v_mfma_f32_16x16x32_bf16 v[92:95], a[52:55], v[148:151], v[92:95]
    v_mfma_f32_16x16x32_bf16 v[80:83], a[56:59], v[152:155], v[80:83]
    ds_read_b128 v[140:143], v228 offset:19456
    s_waitcnt lgkmcnt(7)
    v_mfma_f32_16x16x32_bf16 v[84:87], a[60:63], v[152:155], v[84:87]
    v_mfma_f32_16x16x32_bf16 v[88:91], a[56:59], v[156:159], v[88:91]
    ds_read_b128 v[144:147], v228 offset:20480
    v_mfma_f32_16x16x32_bf16 v[92:95], a[60:63], v[156:159], v[92:95]
    buffer_load_dwordx3 v[124:126], v224, s[44:47], s63 offen offset:2304 sc1
    v_mfma_f32_16x16x32_bf16 v[80:83], a[64:67], v[160:163], v[80:83]
    ds_read_b128 v[148:151], v228 offset:22528
    s_waitcnt lgkmcnt(7)
    v_mfma_f32_16x16x32_bf16 v[84:87], a[68:71], v[160:163], v[84:87]
    v_mfma_f32_16x16x32_bf16 v[88:91], a[64:67], v[164:167], v[88:91]
    ds_read_b128 v[152:155], v228 offset:21504
    v_mfma_f32_16x16x32_bf16 v[92:95], a[68:71], v[164:167], v[92:95]
    v_mfma_f32_16x16x32_bf16 v[80:83], a[72:75], v[168:171], v[80:83]
    ds_read_b128 v[156:159], v228 offset:23552
    s_waitcnt lgkmcnt(7)
    v_mfma_f32_16x16x32_bf16 v[84:87], a[76:79], v[168:171], v[84:87]
    v_mfma_f32_16x16x32_bf16 v[88:91], a[72:75], v[172:175], v[88:91]
    s_waitcnt vmcnt(8)
    s_barrier
    ds_read_b128 v[160:163], v228 offset:24576
    v_mfma_f32_16x16x32_bf16 v[92:95], a[76:79], v[172:175], v[92:95]
    v_mfma_f32_16x16x32_bf16 v[80:83], a[80:83], v[128:131], v[80:83]
    ds_read_b128 v[164:167], v228 offset:26624
    s_waitcnt lgkmcnt(7)
    v_mfma_f32_16x16x32_bf16 v[84:87], a[84:87], v[128:131], v[84:87]
L_D2_14:
    s_cbranch_execz L_DW2
    v_mfma_f32_16x16x32_bf16 v[88:91], a[80:83], v[132:135], v[88:91]
    ds_read_b128 v[168:171], v228 offset:25600
    v_xor_b32 v96, v227, v96
    v_mfma_f32_16x16x32_bf16 v[92:95], a[84:87], v[132:135], v[92:95]
    v_xor_b32 v100, v227, v100
    v_xor_b32 v104, v227, v104
    v_mfma_f32_16x16x32_bf16 v[80:83], a[88:91], v[136:139], v[80:83]
    ds_read_b128 v[172:175], v228 offset:27648
    s_waitcnt lgkmcnt(7)
    v_mfma_f32_16x16x32_bf16 v[84:87], a[92:95], v[136:139], v[84:87]
    v_xor_b32 v108, v227, v108
    v_perm_b32 v99, v98, v97, s84
    v_mfma_f32_16x16x32_bf16 v[88:91], a[88:91], v[140:143], v[88:91]
    ds_read_b128 v[128:131], v228 offset:28672
    v_perm_b32 v103, v102, v101, s84
    v_mfma_f32_16x16x32_bf16 v[92:95], a[92:95], v[140:143], v[92:95]
    v_perm_b32 v107, v106, v105, s84
    v_perm_b32 v111, v110, v109, s84
    v_mfma_f32_16x16x32_bf16 v[80:83], a[96:99], v[144:147], v[80:83]
    ds_read_b128 v[132:135], v228 offset:30720
    s_waitcnt lgkmcnt(7)
    v_mfma_f32_16x16x32_bf16 v[84:87], a[100:103], v[144:147], v[84:87]
    v_or3_b32 v230, v96, v100, v104
    v_or_b32 v230, v230, v108
    v_mfma_f32_16x16x32_bf16 v[88:91], a[96:99], v[148:151], v[88:91]
    ds_read_b128 v[136:139], v228 offset:29696
    v_and_b32 v230, s80, v230
    v_mfma_f32_16x16x32_bf16 v[92:95], a[100:103], v[148:151], v[92:95]
    v_perm_b32 v99, v99, v96, s85
    v_perm_b32 v103, v103, v100, s85
    v_mfma_f32_16x16x32_bf16 v[80:83], a[104:107], v[152:155], v[80:83]
    ds_read_b128 v[140:143], v228 offset:31744
    s_waitcnt lgkmcnt(7)
    v_mfma_f32_16x16x32_bf16 v[84:87], a[108:111], v[152:155], v[84:87]
    v_perm_b32 v107, v107, v104, s85
    v_perm_b32 v111, v111, v108, s85
    v_mfma_f32_16x16x32_bf16 v[88:91], a[104:107], v[156:159], v[88:91]
    ds_read_b128 v[144:147], v228 offset:40960
    v_mfma_f32_16x16x32_bf16 v[92:95], a[108:111], v[156:159], v[92:95]
    v_cmp_ne_u32 vcc, 0, v230
    s_cbranch_vccnz L_PR0
L_PG0:
    v_mfma_f32_16x16x32_bf16 v[80:83], a[112:115], v[160:163], v[80:83]
    ds_read_b128 v[148:151], v228 offset:43008
    s_waitcnt lgkmcnt(7)
    v_mfma_f32_16x16x32_bf16 v[84:87], a[116:119], v[160:163], v[84:87]
    v_mfma_f32_16x16x32_bf16 v[88:91], a[112:115], v[164:167], v[88:91]
    ds_read_b128 v[152:155], v228 offset:41984
    v_mfma_f32_16x16x32_bf16 v[92:95], a[116:119], v[164:167], v[92:95]
    v_mfma_f32_16x16x32_bf16 v[80:83], a[120:123], v[168:171], v[80:83]
    ds_read_b128 v[156:159], v228 offset:44032
    s_waitcnt lgkmcnt(7)
    v_mfma_f32_16x16x32_bf16 v[84:87], a[124:127], v[168:171], v[84:87]
    v_mfma_f32_16x16x32_bf16 v[88:91], a[120:123], v[172:175], v[88:91]
    ds_read_b128 v[160:163], v228 offset:45056
    v_mfma_f32_16x16x32_bf16 v[92:95], a[124:127], v[172:175], v[92:95]
    v_mfma_f32_16x16x32_bf16 v[80:83], v[0:3], v[128:131], v[80:83]
    ds_read_b128 v[164:167], v228 offset:47104
    s_waitcnt lgkmcnt(7)
    v_mfma_f32_16x16x32_bf16 v[84:87], v[4:7], v[128:131], v[84:87]
    s_add_u32 s63, s91, 32768
    v_mfma_f32_16x16x32_bf16 v[88:91], v[0:3], v[132:135], v[88:91]
    ds_read_b128 v[168:171], v228 offset:46080
    v_mfma_f32_16x16x32_bf16 v[92:95], v[4:7], v[132:135], v[92:95]
    buffer_load_dwordx3 v[64:66], v224, s[44:47], s63 offen offset:0 sc1
    v_mfma_f32_16x16x32_bf16 v[80:83], v[8:11], v[136:139], v[80:83]
    ds_read_b128 v[172:175], v228 offset:48128
    s_waitcnt lgkmcnt(7)
    v_mfma_f32_16x16x32_bf16 v[84:87], v[12:15], v[136:139], v[84:87]
    buffer_load_dwordx3 v[68:70], v224, s[44:47], s63 offen offset:768 sc1
    v_mfma_f32_16x16x32_bf16 v[88:91], v[8:11], v[140:143], v[88:91]
    buffer_load_dwordx3 v[72:74], v224, s[44:47], s63 offen offset:1536 sc1
L_D2_15:
    s_cbranch_execz L_D2_16
    v_mfma_f32_16x16x32_bf16 v[92:95], v[12:15], v[140:143], v[92:95]
    buffer_load_dwordx3 v[76:78], v224, s[44:47], s63 offen offset:2304 sc1
    v_mfma_f32_16x16x32_bf16 v[80:83], v[16:19], v[144:147], v[80:83]
    s_waitcnt lgkmcnt(5)
    v_mfma_f32_16x16x32_bf16 v[84:87], v[20:23], v[144:147], v[84:87]
    v_mfma_f32_16x16x32_bf16 v[88:91], v[16:19], v[148:151], v[88:91]
    v_mfma_f32_16x16x32_bf16 v[92:95], v[20:23], v[148:151], v[92:95]
    v_mfma_f32_16x16x32_bf16 v[80:83], v[24:27], v[152:155], v[80:83]
    s_waitcnt lgkmcnt(3)
    v_mfma_f32_16x16x32_bf16 v[84:87], v[28:31], v[152:155], v[84:87]
    v_mfma_f32_16x16x32_bf16 v[88:91], v[24:27], v[156:159], v[88:91]
    v_mfma_f32_16x16x32_bf16 v[92:95], v[28:31], v[156:159], v[92:95]
    v_mfma_f32_16x16x32_bf16 v[80:83], v[32:35], v[160:163], v[80:83]
    s_waitcnt lgkmcnt(1)
    v_mfma_f32_16x16x32_bf16 v[84:87], v[36:39], v[160:163], v[84:87]
    s_waitcnt vmcnt(4)
    v_mfma_f32_16x16x32_bf16 v[88:91], v[32:35], v[164:167], v[88:91]
    v_xor_b32 v112, v227, v112
    v_xor_b32 v116, v227, v116
    v_mfma_f32_16x16x32_bf16 v[92:95], v[36:39], v[164:167], v[92:95]
    v_xor_b32 v120, v227, v120
    v_xor_b32 v124, v227, v124
    v_mfma_f32_16x16x32_bf16 v[80:83], v[40:43], v[168:171], v[80:83]
    v_perm_b32 v115, v114, v113, s84
    v_perm_b32 v119, v118, v117, s84
    s_waitcnt lgkmcnt(0)
    v_mfma_f32_16x16x32_bf16 v[84:87], v[44:47], v[168:171], v[84:87]
    v_perm_b32 v123, v122, v121, s84
    v_perm_b32 v127, v126, v125, s84
    v_mfma_f32_16x16x32_bf16 v[88:91], v[40:43], v[172:175], v[88:91]
    v_or3_b32 v230, v112, v116, v120
    v_or_b32 v230, v230, v124
    v_mfma_f32_16x16x32_bf16 v[92:95], v[44:47], v[172:175], v[92:95]
    v_and_b32 v230, s80, v230
    v_perm_b32 v115, v115, v112, s85
    v_perm_b32 v119, v119, v116, s85
    v_perm_b32 v123, v123, v120, s85
    v_perm_b32 v127, v127, v124, s85
    v_cmp_ne_u32 vcc, 0, v230
    s_cbranch_vccnz L_PR1
L_PG1:
    v_pk_add_f32 v[80:81], v[80:81], v[96:97]
    v_pk_add_f32 v[82:83], v[82:83], v[98:99]
    v_pk_add_f32 v[84:85], v[84:85], v[100:101]
    v_pk_add_f32 v[86:87], v[86:87], v[102:103]
    v_pk_add_f32 v[88:89], v[88:89], v[104:105]
    v_pk_add_f32 v[90:91], v[90:91], v[106:107]
    v_pk_add_f32 v[92:93], v[92:93], v[108:109]
    v_pk_add_f32 v[94:95], v[94:95], v[110:111]
    v_pk_add_f32 v[80:81], v[80:81], v[112:113]
    v_pk_add_f32 v[82:83], v[82:83], v[114:115]
    v_pk_add_f32 v[84:85], v[84:85], v[116:117]
    v_pk_add_f32 v[86:87], v[86:87], v[118:119]
    v_pk_add_f32 v[88:89], v[88:89], v[120:121]
    v_pk_add_f32 v[90:91], v[90:91], v[122:123]
    v_pk_add_f32 v[92:93], v[92:93], v[124:125]
    v_pk_add_f32 v[94:95], v[94:95], v[126:127]
    s_waitcnt vmcnt(0)
    v_xor_b32 v64, v227, v64
    v_xor_b32 v68, v227, v68
    v_xor_b32 v72, v227, v72
    v_xor_b32 v76, v227, v76
    v_perm_b32 v67, v66, v65, s84
    v_perm_b32 v71, v70, v69, s84
    v_perm_b32 v75, v74, v73, s84
    v_perm_b32 v79, v78, v77, s84
    v_or3_b32 v230, v64, v68, v72
    v_or_b32 v230, v230, v76
    v_and_b32 v230, s80, v230
    v_perm_b32 v67, v67, v64, s85
    v_perm_b32 v71, v71, v68, s85
    v_perm_b32 v75, v75, v72, s85
    v_perm_b32 v79, v79, v76, s85
    v_cmp_ne_u32 vcc, 0, v230
    s_cbranch_vccnz L_PR2
L_PG2:
L_D2_16:
    s_cbranch_execz L_DW2
    v_pk_add_f32 v[80:81], v[80:81], v[64:65]
    v_pk_add_f32 v[82:83], v[82:83], v[66:67]
    v_pk_add_f32 v[84:85], v[84:85], v[68:69]
    v_pk_add_f32 v[86:87], v[86:87], v[70:71]
    v_cvt_pk_bf16_f32 v128, v80, v81
    v_cvt_pk_bf16_f32 v129, v82, v83
    v_cvt_pk_bf16_f32 v130, v84, v85
    v_cvt_pk_bf16_f32 v131, v86, v87
    s_add_u32 s61, s92, 0
    v_permlane16_swap_b32 v128, v130
    v_permlane16_swap_b32 v129, v131
    buffer_store_dwordx4 v[128:131], v226, s[36:39], s61 offen
    v_pk_add_f32 v[88:89], v[88:89], v[72:73]
    v_pk_add_f32 v[90:91], v[90:91], v[74:75]
    v_pk_add_f32 v[92:93], v[92:93], v[76:77]
    v_pk_add_f32 v[94:95], v[94:95], v[78:79]
    v_cvt_pk_bf16_f32 v132, v88, v89
    v_cvt_pk_bf16_f32 v133, v90, v91
    v_cvt_pk_bf16_f32 v134, v92, v93
    v_cvt_pk_bf16_f32 v135, v94, v95
    s_add_u32 s61, s92, 32768
    v_permlane16_swap_b32 v132, v134
    v_permlane16_swap_b32 v133, v135
    buffer_store_dwordx4 v[132:135], v226, s[36:39], s61 offen
L_END:
    s_endpgm
L_SF0:
    s_mov_b32 s68, 9437184
    buffer_load_dwordx2 v[232:233], v253, s[44:47], s72 offen offset:0 sc1
    s_branch L_SR0
L_SF1:
    s_mov_b32 s68, 9437184
    buffer_load_dwordx2 v[232:233], v253, s[44:47], s72 offen offset:128 sc1
    s_branch L_SR1
L_SF2:
    s_mov_b32 s68, 9437184
    buffer_load_dwordx2 v[232:233], v253, s[44:47], s72 offen offset:256 sc1
    s_branch L_SR2
L_SF3:
    s_mov_b32 s68, 9437184
    buffer_load_dwordx2 v[232:233], v253, s[44:47], s72 offen offset:384 sc1
    s_branch L_SR3
L_FIX0_0:
    s_waitcnt vmcnt(15)
    v_cmp_ne_u64 vcc, v[232:233], s[96:97]
    s_cbranch_vccz L_POK0_0
    buffer_load_dwordx2 v[232:233], v253, s[44:47], s72 offen offset:0 sc1
    s_branch L_FOK0_0
L_POK0_0:
    s_mov_b32 s68, s73
    buffer_load_dwordx2 v[250:251], v253, s[44:47], s72 offen offset:128 sc1
    s_add_u32 m0, s56, 49152
    s_bfe_u32 s16, s49, 0x40000
    s_lshl_b32 s16, s16, 11
    s_add_u32 s16, s16, s68
    buffer_load_dwordx4 v252, s[44:47], s16 offen lds
    buffer_load_dwordx4 v252, s[44:47], s16 offen offset:1024 lds
    s_add_u32 m0, s56, 98304
    s_bfe_u32 s17, s49, 0x40004
    s_lshl_b32 s17, s17, 11
    s_add_u32 s17, s17, s68
    buffer_load_dwordx4 v252, s[44:47], s17 offen lds
    buffer_load_dwordx4 v252, s[44:47], s17 offen offset:1024 lds
    s_add_u32 m0, s56, 114688
    s_bfe_u32 s16, s49, 0x40008
    s_lshl_b32 s16, s16, 11
    s_add_u32 s16, s16, s68
    buffer_load_dwordx4 v252, s[44:47], s16 offen lds
    buffer_load_dwordx4 v252, s[44:47], s16 offen offset:1024 lds
    s_add_u32 m0, s56, 122880
    s_bfe_u32 s17, s49, 0x4000c
    s_lshl_b32 s17, s17, 11
    s_add_u32 s17, s17, s68
    buffer_load_dwordx4 v252, s[44:47], s17 offen lds
    buffer_load_dwordx4 v252, s[44:47], s17 offen offset:1024 lds
    s_add_u32 m0, s56, 147456
    s_bfe_u32 s16, s49, 0x40010
    s_lshl_b32 s16, s16, 11
    s_add_u32 s16, s16, s68
    buffer_load_dwordx4 v252, s[44:47], s16 offen lds
    buffer_load_dwordx4 v252, s[44:47], s16 offen offset:1024 lds
    s_add_u32 m0, s56, 106496
    s_bfe_u32 s17, s49, 0x40014
L_D2_17:
    s_cbranch_execz L_DW2
    s_lshl_b32 s17, s17, 11
    s_add_u32 s17, s17, s68
    buffer_load_dwordx4 v252, s[44:47], s17 offen lds
    buffer_load_dwordx4 v252, s[44:47], s17 offen offset:1024 lds
    buffer_load_dwordx4 v252, s[44:47], s17 offen offset:1024 lds
    buffer_load_dwordx4 v252, s[44:47], s17 offen offset:1024 lds
    s_branch L_FOK0_0
L_FIX0:
    s_waitcnt vmcnt(1)
    v_cmp_ne_u64 vcc, v[232:233], s[96:97]
    s_mov_b32 s64, 40000
    s_cbranch_vccz L_POK0
    buffer_load_dwordx2 v[232:233], v253, s[44:47], s72 offen offset:0 sc1
L_POLLB0:
    s_waitcnt vmcnt(0)
    v_cmp_ne_u64 vcc, v[232:233], s[96:97]
    s_sub_u32 s64, s64, 1
    s_cbranch_vccz L_POK0
    s_cmp_eq_u32 s64, 0
    s_cbranch_scc1 L_POK0
    buffer_load_dwordx2 v[232:233], v253, s[44:47], s72 offen offset:0 sc1
    s_branch L_POLLB0
L_POK0:
    s_mov_b32 s68, s73
    buffer_load_dwordx2 v[250:251], v253, s[44:47], s72 offen offset:128 sc1
    s_add_u32 m0, s56, 49152
    s_bfe_u32 s16, s49, 0x40000
    s_lshl_b32 s16, s16, 11
    s_add_u32 s16, s16, s68
    buffer_load_dwordx4 v252, s[44:47], s16 offen lds
    buffer_load_dwordx4 v252, s[44:47], s16 offen offset:1024 lds
    s_add_u32 m0, s56, 98304
    s_bfe_u32 s17, s49, 0x40004
    s_lshl_b32 s17, s17, 11
    s_add_u32 s17, s17, s68
    buffer_load_dwordx4 v252, s[44:47], s17 offen lds
    buffer_load_dwordx4 v252, s[44:47], s17 offen offset:1024 lds
    s_add_u32 m0, s56, 114688
    s_bfe_u32 s16, s49, 0x40008
    s_lshl_b32 s16, s16, 11
    s_add_u32 s16, s16, s68
    buffer_load_dwordx4 v252, s[44:47], s16 offen lds
    buffer_load_dwordx4 v252, s[44:47], s16 offen offset:1024 lds
    s_add_u32 m0, s56, 122880
    s_bfe_u32 s17, s49, 0x4000c
    s_lshl_b32 s17, s17, 11
    s_add_u32 s17, s17, s68
    buffer_load_dwordx4 v252, s[44:47], s17 offen lds
    buffer_load_dwordx4 v252, s[44:47], s17 offen offset:1024 lds
    s_add_u32 m0, s56, 147456
    s_bfe_u32 s16, s49, 0x40010
    s_lshl_b32 s16, s16, 11
    s_add_u32 s16, s16, s68
    buffer_load_dwordx4 v252, s[44:47], s16 offen lds
    buffer_load_dwordx4 v252, s[44:47], s16 offen offset:1024 lds
    s_add_u32 m0, s56, 106496
    s_bfe_u32 s17, s49, 0x40014
    s_lshl_b32 s17, s17, 11
    s_add_u32 s17, s17, s68
    buffer_load_dwordx4 v252, s[44:47], s17 offen lds
    buffer_load_dwordx4 v252, s[44:47], s17 offen offset:1024 lds
    buffer_load_dwordx4 v252, s[44:47], s17 offen offset:1024 lds
    buffer_load_dwordx4 v252, s[44:47], s17 offen offset:1024 lds
    s_add_u32 m0, s56, 57344
    s_bfe_u32 s16, s49, 0x40018
    s_lshl_b32 s16, s16, 11
    s_add_u32 s16, s16, s68
    buffer_load_dwordx4 v252, s[44:47], s16 offen lds
    s_branch L_FOK0
L_FIX1_2:
    s_waitcnt vmcnt(10)
    v_cmp_ne_u64 vcc, v[232:233], s[96:97]
    s_cbranch_vccz L_POK1_2
    buffer_load_dwordx2 v[232:233], v253, s[44:47], s72 offen offset:128 sc1
    s_branch L_FOK1_2
L_POK1_2:
    s_mov_b32 s68, s73
    s_add_u32 m0, s56, 155648
    s_bfe_u32 s17, s49, 0x40000
    s_lshl_b32 s17, s17, 11
    s_add_u32 s17, s17, s68
    buffer_load_dwordx4 v252, s[44:47], s17 offen lds
    buffer_load_dwordx4 v252, s[44:47], s17 offen offset:1024 lds
    s_add_u32 m0, s56, 16384
    s_bfe_u32 s16, s49, 0x40004
L_D2_18:
    s_cbranch_execz L_D2_19
    s_lshl_b32 s16, s16, 11
    s_add_u32 s16, s16, s68
    buffer_load_dwordx4 v252, s[44:47], s16 offen lds
    buffer_load_dwordx4 v252, s[44:47], s16 offen offset:1024 lds
    s_add_u32 m0, s56, 24576
    s_bfe_u32 s17, s49, 0x40008
    s_lshl_b32 s17, s17, 11
    s_add_u32 s17, s17, s68
    buffer_load_dwordx4 v252, s[44:47], s17 offen lds
    buffer_load_dwordx4 v252, s[44:47], s17 offen offset:1024 lds
    s_add_u32 m0, s56, 49152
    s_bfe_u32 s16, s49, 0x4000c
    s_lshl_b32 s16, s16, 11
    s_add_u32 s16, s16, s68
    buffer_load_dwordx4 v252, s[44:47], s16 offen lds
    buffer_load_dwordx4 v252, s[44:47], s16 offen offset:1024 lds
    buffer_load_dwordx4 v252, s[44:47], s16 offen offset:1024 lds
    s_add_u32 m0, s56, 139264
    s_bfe_u32 s17, s49, 0x40010
    s_lshl_b32 s17, s17, 11
    s_add_u32 s17, s17, s68
    buffer_load_dwordx4 v252, s[44:47], s17 offen lds
    s_branch L_FOK1_2
L_FIX1:
    s_waitcnt vmcnt(5)
    v_cmp_ne_u64 vcc, v[232:233], s[96:97]
    s_mov_b32 s64, 40000
    s_cbranch_vccz L_POK1
    buffer_load_dwordx2 v[232:233], v253, s[44:47], s72 offen offset:128 sc1
L_POLLB1:
    s_waitcnt vmcnt(0)
    v_cmp_ne_u64 vcc, v[232:233], s[96:97]
    s_sub_u32 s64, s64, 1
    s_cbranch_vccz L_POK1
    s_cmp_eq_u32 s64, 0
    s_cbranch_scc1 L_POK1
    buffer_load_dwordx2 v[232:233], v253, s[44:47], s72 offen offset:128 sc1
    s_branch L_POLLB1
L_POK1:
    s_mov_b32 s68, s73
    s_add_u32 m0, s56, 155648
    s_bfe_u32 s17, s49, 0x40000
    s_lshl_b32 s17, s17, 11
    s_add_u32 s17, s17, s68
    buffer_load_dwordx4 v252, s[44:47], s17 offen lds
    buffer_load_dwordx4 v252, s[44:47], s17 offen offset:1024 lds
    s_add_u32 m0, s56, 16384
    s_bfe_u32 s16, s49, 0x40004
    s_lshl_b32 s16, s16, 11
    s_add_u32 s16, s16, s68
    buffer_load_dwordx4 v252, s[44:47], s16 offen lds
    buffer_load_dwordx4 v252, s[44:47], s16 offen offset:1024 lds
    s_add_u32 m0, s56, 24576
    s_bfe_u32 s17, s49, 0x40008
    s_lshl_b32 s17, s17, 11
    s_add_u32 s17, s17, s68
    buffer_load_dwordx4 v252, s[44:47], s17 offen lds
    buffer_load_dwordx4 v252, s[44:47], s17 offen offset:1024 lds
    s_add_u32 m0, s56, 49152
    s_bfe_u32 s16, s49, 0x4000c
    s_lshl_b32 s16, s16, 11
    s_add_u32 s16, s16, s68
    buffer_load_dwordx4 v252, s[44:47], s16 offen lds
    buffer_load_dwordx4 v252, s[44:47], s16 offen offset:1024 lds
    s_add_u32 m0, s56, 139264
    s_bfe_u32 s17, s49, 0x40010
    s_lshl_b32 s17, s17, 11
    s_add_u32 s17, s17, s68
    buffer_load_dwordx4 v252, s[44:47], s17 offen lds
    buffer_load_dwordx4 v252, s[44:47], s17 offen offset:1024 lds
    s_add_u32 m0, s56, 131072
    s_bfe_u32 s16, s49, 0x40014
    s_lshl_b32 s16, s16, 11
    s_add_u32 s16, s16, s68
    buffer_load_dwordx4 v252, s[44:47], s16 offen lds
    buffer_load_dwordx4 v252, s[44:47], s16 offen offset:1024 lds
    buffer_load_dwordx4 v252, s[44:47], s16 offen offset:1024 lds
    buffer_load_dwordx4 v252, s[44:47], s16 offen offset:1024 lds
    s_add_u32 m0, s56, 98304
    s_bfe_u32 s17, s49, 0x40018
    s_lshl_b32 s17, s17, 11
    s_add_u32 s17, s17, s68
L_D2_19:
    s_cbranch_execz L_DW2
    buffer_load_dwordx4 v252, s[44:47], s17 offen lds
    s_branch L_FOK1
L_FIX2_4:
    s_waitcnt vmcnt(12)
    v_cmp_ne_u64 vcc, v[232:233], s[96:97]
    s_cbranch_vccz L_POK2_4
    buffer_load_dwordx2 v[232:233], v253, s[44:47], s72 offen offset:256 sc1
    s_branch L_FOK2_4
L_POK2_4:
    s_mov_b32 s68, s73
    s_add_u32 m0, s56, 147456
    s_bfe_u32 s16, s49, 0x40000
    s_lshl_b32 s16, s16, 11
    s_add_u32 s16, s16, s68
    buffer_load_dwordx4 v252, s[44:47], s16 offen lds
    buffer_load_dwordx4 v252, s[44:47], s16 offen offset:1024 lds
    s_add_u32 m0, s56, 106496
    s_bfe_u32 s17, s49, 0x40004
    s_lshl_b32 s17, s17, 11
    s_add_u32 s17, s17, s68
    buffer_load_dwordx4 v252, s[44:47], s17 offen lds
    buffer_load_dwordx4 v252, s[44:47], s17 offen offset:1024 lds
    s_add_u32 m0, s56, 57344
    s_bfe_u32 s16, s49, 0x40008
    s_lshl_b32 s16, s16, 11
    s_add_u32 s16, s16, s68
    buffer_load_dwordx4 v252, s[44:47], s16 offen lds
    buffer_load_dwordx4 v252, s[44:47], s16 offen offset:1024 lds
    s_add_u32 m0, s56, 8192
    s_bfe_u32 s17, s49, 0x4000c
    s_lshl_b32 s17, s17, 11
    s_add_u32 s17, s17, s68
    buffer_load_dwordx4 v252, s[44:47], s17 offen lds
    buffer_load_dwordx4 v252, s[44:47], s17 offen offset:1024 lds
    s_add_u32 m0, s56, 0
    s_bfe_u32 s16, s49, 0x40010
    s_lshl_b32 s16, s16, 11
    s_add_u32 s16, s16, s68
    buffer_load_dwordx4 v252, s[44:47], s16 offen lds
    buffer_load_dwordx4 v252, s[44:47], s16 offen offset:1024 lds
    buffer_load_dwordx4 v252, s[44:47], s16 offen offset:1024 lds
    buffer_load_dwordx4 v252, s[44:47], s16 offen offset:1024 lds
    s_bfe_u32 s17, s49, 0x40014
    s_lshl_b32 s17, s17, 11
    s_add_u32 s17, s17, s68
    s_branch L_FOK2_4
L_FIX2:
    s_waitcnt vmcnt(6)
    v_cmp_ne_u64 vcc, v[232:233], s[96:97]
    s_mov_b32 s64, 40000
    s_cbranch_vccz L_POK2
    buffer_load_dwordx2 v[232:233], v253, s[44:47], s72 offen offset:256 sc1
L_POLLB2:
    s_waitcnt vmcnt(0)
    v_cmp_ne_u64 vcc, v[232:233], s[96:97]
    s_sub_u32 s64, s64, 1
    s_cbranch_vccz L_POK2
    s_cmp_eq_u32 s64, 0
    s_cbranch_scc1 L_POK2
    buffer_load_dwordx2 v[232:233], v253, s[44:47], s72 offen offset:256 sc1
    s_branch L_POLLB2
L_POK2:
    s_mov_b32 s68, s73
    s_add_u32 m0, s56, 147456
    s_bfe_u32 s16, s49, 0x40000
    s_lshl_b32 s16, s16, 11
    s_add_u32 s16, s16, s68
    buffer_load_dwordx4 v252, s[44:47], s16 offen lds
    buffer_load_dwordx4 v252, s[44:47], s16 offen offset:1024 lds
    s_add_u32 m0, s56, 106496
    s_bfe_u32 s17, s49, 0x40004
    s_lshl_b32 s17, s17, 11
    s_add_u32 s17, s17, s68
    buffer_load_dwordx4 v252, s[44:47], s17 offen lds
    buffer_load_dwordx4 v252, s[44:47], s17 offen offset:1024 lds
    s_add_u32 m0, s56, 57344
    s_bfe_u32 s16, s49, 0x40008
    s_lshl_b32 s16, s16, 11
    s_add_u32 s16, s16, s68
    buffer_load_dwordx4 v252, s[44:47], s16 offen lds
    buffer_load_dwordx4 v252, s[44:47], s16 offen offset:1024 lds
    s_add_u32 m0, s56, 8192
    s_bfe_u32 s17, s49, 0x4000c
    s_lshl_b32 s17, s17, 11
    s_add_u32 s17, s17, s68
    buffer_load_dwordx4 v252, s[44:47], s17 offen lds
    buffer_load_dwordx4 v252, s[44:47], s17 offen offset:1024 lds
L_ST7:
    s_cbranch_execz L_WALKED
L_D2_20:
    s_cbranch_execz L_DW2
    s_add_u32 m0, s56, 0
    s_bfe_u32 s16, s49, 0x40010
    s_lshl_b32 s16, s16, 11
    s_add_u32 s16, s16, s68
    buffer_load_dwordx4 v252, s[44:47], s16 offen lds
    buffer_load_dwordx4 v252, s[44:47], s16 offen offset:1024 lds
    s_add_u32 m0, s56, 155648
    s_bfe_u32 s17, s49, 0x40014
    s_lshl_b32 s17, s17, 11
    s_add_u32 s17, s17, s68
    buffer_load_dwordx4 v252, s[44:47], s17 offen lds
    buffer_load_dwordx4 v252, s[44:47], s17 offen offset:1024 lds
    buffer_load_dwordx4 v252, s[44:47], s17 offen offset:1024 lds
    buffer_load_dwordx4 v252, s[44:47], s17 offen offset:1024 lds
    buffer_load_dwordx4 v252, s[44:47], s17 offen offset:1024 lds
    buffer_load_dwordx4 v252, s[44:47], s17 offen offset:1024 lds
    buffer_load_dwordx4 v252, s[44:47], s17 offen offset:1024 lds
    s_add_u32 m0, s56, 49152
    s_bfe_u32 s16, s49, 0x40018
    s_lshl_b32 s16, s16, 11
    s_add_u32 s16, s16, s68
    buffer_load_dwordx4 v252, s[44:47], s16 offen lds
    s_branch L_FOK2
L_FIX3_6:
    s_waitcnt vmcnt(12)
    v_cmp_ne_u64 vcc, v[232:233], s[96:97]
    s_cbranch_vccz L_POK3_6
    buffer_load_dwordx2 v[232:233], v253, s[44:47], s72 offen offset:384 sc1
    s_branch L_FOK3_6
L_POK3_6:
    s_mov_b32 s68, s73
    s_add_u32 m0, s56, 32768
    s_bfe_u32 s17, s49, 0x40000
    s_lshl_b32 s17, s17, 11
    s_add_u32 s17, s17, s68
    buffer_load_dwordx4 v252, s[44:47], s17 offen lds
    buffer_load_dwordx4 v252, s[44:47], s17 offen offset:1024 lds
    s_add_u32 m0, s56, 40960
    s_bfe_u32 s16, s49, 0x40004
    s_lshl_b32 s16, s16, 11
    s_add_u32 s16, s16, s68
    buffer_load_dwordx4 v252, s[44:47], s16 offen lds
    buffer_load_dwordx4 v252, s[44:47], s16 offen offset:1024 lds
    s_add_u32 m0, s56, 98304
    s_bfe_u32 s17, s49, 0x40008
    s_lshl_b32 s17, s17, 11
    s_add_u32 s17, s17, s68
    buffer_load_dwordx4 v252, s[44:47], s17 offen lds
    buffer_load_dwordx4 v252, s[44:47], s17 offen offset:1024 lds
    s_add_u32 m0, s56, 147456
    s_bfe_u32 s16, s49, 0x4000c
    s_lshl_b32 s16, s16, 11
    s_add_u32 s16, s16, s68
    buffer_load_dwordx4 v252, s[44:47], s16 offen lds
    buffer_load_dwordx4 v252, s[44:47], s16 offen offset:1024 lds
    s_add_u32 m0, s56, 81920
    s_bfe_u32 s17, s49, 0x40010
    s_lshl_b32 s17, s17, 11
    s_add_u32 s17, s17, s68
    buffer_load_dwordx4 v252, s[44:47], s17 offen lds
    buffer_load_dwordx4 v252, s[44:47], s17 offen offset:1024 lds
    buffer_load_dwordx4 v252, s[44:47], s17 offen offset:1024 lds
    buffer_load_dwordx4 v252, s[44:47], s17 offen offset:1024 lds
    s_branch L_FOK3_6
L_FIX3:
    s_waitcnt vmcnt(2)
    v_cmp_ne_u64 vcc, v[232:233], s[96:97]
    s_mov_b32 s64, 40000
    s_cbranch_vccz L_POK3
    buffer_load_dwordx2 v[232:233], v253, s[44:47], s72 offen offset:384 sc1
L_POLLB3:
    s_waitcnt vmcnt(0)
    v_cmp_ne_u64 vcc, v[232:233], s[96:97]
    s_sub_u32 s64, s64, 1
    s_cbranch_vccz L_POK3
    s_cmp_eq_u32 s64, 0
    s_cbranch_scc1 L_POK3
    buffer_load_dwordx2 v[232:233], v253, s[44:47], s72 offen offset:384 sc1
    s_branch L_POLLB3
L_POK3:
    s_mov_b32 s68, s73
    s_add_u32 m0, s56, 32768
    s_bfe_u32 s17, s49, 0x40000
    s_lshl_b32 s17, s17, 11
L_D2_21:
    s_cbranch_execz L_D2_22
    s_add_u32 s17, s17, s68
    buffer_load_dwordx4 v252, s[44:47], s17 offen lds
    buffer_load_dwordx4 v252, s[44:47], s17 offen offset:1024 lds
    s_add_u32 m0, s56, 40960
    s_bfe_u32 s16, s49, 0x40004
    s_lshl_b32 s16, s16, 11
    s_add_u32 s16, s16, s68
    buffer_load_dwordx4 v252, s[44:47], s16 offen lds
    buffer_load_dwordx4 v252, s[44:47], s16 offen offset:1024 lds
    s_add_u32 m0, s56, 98304
    s_bfe_u32 s17, s49, 0x40008
    s_lshl_b32 s17, s17, 11
    s_add_u32 s17, s17, s68
    buffer_load_dwordx4 v252, s[44:47], s17 offen lds
    buffer_load_dwordx4 v252, s[44:47], s17 offen offset:1024 lds
    s_add_u32 m0, s56, 147456
    s_bfe_u32 s16, s49, 0x4000c
    s_lshl_b32 s16, s16, 11
    s_add_u32 s16, s16, s68
    buffer_load_dwordx4 v252, s[44:47], s16 offen lds
    buffer_load_dwordx4 v252, s[44:47], s16 offen offset:1024 lds
    s_add_u32 m0, s56, 81920
    s_bfe_u32 s17, s49, 0x40010
    s_lshl_b32 s17, s17, 11
    s_add_u32 s17, s17, s68
    buffer_load_dwordx4 v252, s[44:47], s17 offen lds
    buffer_load_dwordx4 v252, s[44:47], s17 offen offset:1024 lds
    buffer_load_dwordx4 v252, s[44:47], s17 offen offset:1024 lds
    buffer_load_dwordx4 v252, s[44:47], s17 offen offset:1024 lds
    buffer_load_dwordx4 v252, s[44:47], s17 offen offset:1024 lds
    s_add_u32 m0, s56, 90112
    s_bfe_u32 s16, s49, 0x40014
    s_lshl_b32 s16, s16, 11
    s_add_u32 s16, s16, s68
    buffer_load_dwordx4 v252, s[44:47], s16 offen lds
    s_bfe_u32 s17, s49, 0x40018
    s_lshl_b32 s17, s17, 11
    s_add_u32 s17, s17, s68
    s_branch L_FOK3
L_PR0:
    s_cmp_eq_u32 s93, 0
    s_cbranch_scc1 L_PG0
    s_sub_u32 s93, s93, 1
    s_add_u32 s64, s91, 0
    buffer_load_dwordx3 v[96:98], v224, s[44:47], s64 offen offset:0 sc1
    buffer_load_dwordx3 v[100:102], v224, s[44:47], s64 offen offset:768 sc1
    buffer_load_dwordx3 v[104:106], v224, s[44:47], s64 offen offset:1536 sc1
    buffer_load_dwordx3 v[108:110], v224, s[44:47], s64 offen offset:2304 sc1
    s_waitcnt vmcnt(0)
    v_xor_b32 v96, v227, v96
    v_xor_b32 v100, v227, v100
    v_xor_b32 v104, v227, v104
    v_xor_b32 v108, v227, v108
    v_perm_b32 v99, v98, v97, s84
    v_perm_b32 v103, v102, v101, s84
    v_perm_b32 v107, v106, v105, s84
    v_perm_b32 v111, v110, v109, s84
    v_or3_b32 v230, v96, v100, v104
    v_or_b32 v230, v230, v108
    v_and_b32 v230, s80, v230
    v_perm_b32 v99, v99, v96, s85
    v_perm_b32 v103, v103, v100, s85
    v_perm_b32 v107, v107, v104, s85
    v_perm_b32 v111, v111, v108, s85
    v_cmp_ne_u32 vcc, 0, v230
    s_cbranch_vccnz L_PR0
    s_branch L_PG0
L_PR1:
    s_cmp_eq_u32 s93, 0
    s_cbranch_scc1 L_PG1
    s_sub_u32 s93, s93, 1
    s_add_u32 s64, s91, 16384
    buffer_load_dwordx3 v[112:114], v224, s[44:47], s64 offen offset:0 sc1
    buffer_load_dwordx3 v[116:118], v224, s[44:47], s64 offen offset:768 sc1
    buffer_load_dwordx3 v[120:122], v224, s[44:47], s64 offen offset:1536 sc1
    buffer_load_dwordx3 v[124:126], v224, s[44:47], s64 offen offset:2304 sc1
    s_waitcnt vmcnt(0)
    v_xor_b32 v112, v227, v112
    v_xor_b32 v116, v227, v116
    v_xor_b32 v120, v227, v120
    v_xor_b32 v124, v227, v124
    v_perm_b32 v115, v114, v113, s84
    v_perm_b32 v119, v118, v117, s84
    v_perm_b32 v123, v122, v121, s84
L_D2_22:
    s_cbranch_execz L_DW2
    v_perm_b32 v127, v126, v125, s84
    v_or3_b32 v230, v112, v116, v120
    v_or_b32 v230, v230, v124
    v_and_b32 v230, s80, v230
    v_perm_b32 v115, v115, v112, s85
    v_perm_b32 v119, v119, v116, s85
    v_perm_b32 v123, v123, v120, s85
    v_perm_b32 v127, v127, v124, s85
    v_cmp_ne_u32 vcc, 0, v230
    s_cbranch_vccnz L_PR1
    s_branch L_PG1
L_PR2:
    s_cmp_eq_u32 s93, 0
    s_cbranch_scc1 L_PG2
    s_sub_u32 s93, s93, 1
    s_add_u32 s64, s91, 32768
    buffer_load_dwordx3 v[64:66], v224, s[44:47], s64 offen offset:0 sc1
    buffer_load_dwordx3 v[68:70], v224, s[44:47], s64 offen offset:768 sc1
    buffer_load_dwordx3 v[72:74], v224, s[44:47], s64 offen offset:1536 sc1
    buffer_load_dwordx3 v[76:78], v224, s[44:47], s64 offen offset:2304 sc1
    s_waitcnt vmcnt(0)
    v_xor_b32 v64, v227, v64
    v_xor_b32 v68, v227, v68
    v_xor_b32 v72, v227, v72
    v_xor_b32 v76, v227, v76
    v_perm_b32 v67, v66, v65, s84
    v_perm_b32 v71, v70, v69, s84
    v_perm_b32 v75, v74, v73, s84
    v_perm_b32 v79, v78, v77, s84
    v_or3_b32 v230, v64, v68, v72
    v_or_b32 v230, v230, v76
    v_and_b32 v230, s80, v230
    v_perm_b32 v67, v67, v64, s85
    v_perm_b32 v71, v71, v68, s85
    v_perm_b32 v75, v75, v72, s85
    v_perm_b32 v79, v79, v76, s85
    v_cmp_ne_u32 vcc, 0, v230
    s_cbranch_vccnz L_PR2
    s_branch L_PG2
L_NRETRY:
    s_mov_b32 s93, 40000
L_NR1:
    buffer_load_dwordx2 v[248:249], off, s[40:43], 0 sc1
    s_waitcnt vmcnt(0)
    v_readfirstlane_b32 s96, v248
    v_readfirstlane_b32 s97, v249
    s_sub_u32 s93, s93, 1
    s_cmp_eq_u32 s93, 0
    s_cbranch_scc1 L_NOK
    s_cmp_eq_u32 s97, 0
    s_cbranch_scc1 L_NR1
    s_branch L_NOK
L_PFB:
    s_cmp_lg_u32 s2, 255
    s_cbranch_scc1 L_PF1
    s_cmp_lg_u32 s48, 0
    s_cbranch_scc1 L_PF1
    s_memrealtime s[94:95]
    s_waitcnt lgkmcnt(0)
    s_mul_i32 s94, s94, 0x9e3779b1
    s_or_b32 s95, s95, 0x80000000
    v_mov_b32 v248, s94
    v_mov_b32 v249, s95
    s_mov_b64 exec, 1
    buffer_store_dwordx2 v[248:249], off, s[40:43], 0 sc1
    s_mov_b64 exec, -1
L_PF1:
    s_add_u32 s64, s8, 4
    s_min_u32 s64, s64, 15
    s_mul_i32 s64, s64, 458752
    s_add_u32 s64, s64, s11
    s_mov_b32 exec_hi, 0
    buffer_load_dword v137, v132, s[24:27], s64 offen
    s_mov_b32 exec_hi, -1
    s_barrier
    s_add_u32 s64, s4, 917504
    s_mov_b32 exec_lo, 0xf7f7f7f7
    s_mov_b32 exec_hi, 0xf7f7f7f7
    buffer_load_dword v138, v134, s[32:35], s64 offen
    s_mov_b64 exec, -1
    s_barrier
    v_add_u32 v134, 131072, v134
    v_subrev_u32 v135, 917504, v134
    v_min_u32 v134, v134, v135
    s_add_u32 s64, s4, 0
    s_mov_b32 exec_lo, 0xf7f7f7f7
    s_mov_b32 exec_hi, 0xf7f7f7f7
    buffer_load_dword v138, v134, s[32:35], s64 offen
    s_mov_b64 exec, -1
    s_barrier
    s_add_u32 s64, s8, 8
    s_min_u32 s64, s64, 15
    s_mul_i32 s64, s64, 458752
    s_add_u32 s64, s64, s11
    s_mov_b32 exec_hi, 0
    buffer_load_dword v137, v132, s[24:27], s64 offen
    s_mov_b32 exec_hi, -1
    s_barrier
    s_add_u32 s64, s4, 917504
    s_mov_b32 exec_lo, 0xf7f7f7f7
    s_mov_b32 exec_hi, 0xf7f7f7f7
    buffer_load_dword v138, v134, s[32:35], s64 offen
    s_mov_b64 exec, -1
    s_barrier
    v_add_u32 v134, 131072, v134
    v_subrev_u32 v135, 917504, v134
    v_min_u32 v134, v134, v135
    s_add_u32 s64, s4, 0
    s_mov_b32 exec_lo, 0xf7f7f7f7
    s_mov_b32 exec_hi, 0xf7f7f7f7
    buffer_load_dword v138, v134, s[32:35], s64 offen
    s_mov_b64 exec, -1
    s_barrier
    s_add_u32 s64, s4, 917504
    s_mov_b32 exec_lo, 0xf7f7f7f7
    s_mov_b32 exec_hi, 0xf7f7f7f7
    buffer_load_dword v138, v134, s[32:35], s64 offen
    s_mov_b64 exec, -1
    s_barrier
    s_add_u32 s64, s49, 12
    s_min_u32 s64, s64, 15
    s_mul_i32 s64, s64, 458752
    s_add_u32 s64, s64, s11
    s_mov_b32 exec_hi, 0
    buffer_load_dword v137, v132, s[24:27], s64 offen
    s_mov_b32 exec_hi, -1
    s_barrier
    v_add_u32 v134, 131072, v134
    v_subrev_u32 v135, 917504, v134
    v_min_u32 v134, v134, v135
    s_add_u32 s64, s4, 0
    s_mov_b32 exec_lo, 0xf7f7f7f7
    s_mov_b32 exec_hi, 0xf7f7f7f7
    buffer_load_dword v138, v134, s[32:35], s64 offen
    s_mov_b64 exec, -1
    s_barrier
    s_add_u32 s64, s4, 917504
    s_mov_b32 exec_lo, 0xf7f7f7f7
    s_mov_b32 exec_hi, 0xf7f7f7f7
    buffer_load_dword v138, v134, s[32:35], s64 offen
    s_mov_b64 exec, -1
    s_barrier
    v_add_u32 v134, 131072, v134
    v_subrev_u32 v135, 917504, v134
    v_min_u32 v134, v134, v135
    s_add_u32 s64, s4, 0
    s_mov_b32 exec_lo, 0xf7f7f7f7
    s_mov_b32 exec_hi, 0xf7f7f7f7
    buffer_load_dword v138, v134, s[32:35], s64 offen
    s_mov_b64 exec, -1
    s_barrier
    s_add_u32 s64, s4, 917504
    s_mov_b32 exec_lo, 0xf7f7f7f7
    s_mov_b32 exec_hi, 0xf7f7f7f7
    buffer_load_dword v138, v134, s[32:35], s64 offen
    s_mov_b64 exec, -1
    s_barrier
    v_add_u32 v134, 131072, v134
    v_subrev_u32 v135, 917504, v134
    v_min_u32 v134, v134, v135
    s_add_u32 s64, s4, 0
    s_mov_b32 exec_lo, 0xf7f7f7f7
    s_mov_b32 exec_hi, 0xf7f7f7f7
    buffer_load_dword v138, v134, s[32:35], s64 offen
    s_mov_b64 exec, -1
    s_barrier
    s_add_u32 s64, s4, 917504
    s_mov_b32 exec_lo, 0xf7f7f7f7
    s_mov_b32 exec_hi, 0xf7f7f7f7
    buffer_load_dword v138, v134, s[32:35], s64 offen
    s_mov_b64 exec, -1
    s_barrier
    s_lshl2_add_u32 s64, s49, s48
    s_lshl_b32 s64, s64, 13
    s_mul_i32 s63, s65, 1835008
    s_add_u32 s64, s64, s63
    s_add_u32 s64, s64, 0
    v_bfe_u32 v136, v254, 2, 3
    v_min_u32 v136, 6, v136
    v_lshlrev_b32 v136, 17, v136
    v_and_b32 v135, 3, v254
    v_lshl_add_u32 v136, v135, 11, v136
    v_lshrrev_b32 v135, 5, v254
    v_lshl_add_u32 v136, v135, 10, v136
    buffer_load_dword v138, v136, s[32:35], s64 offen offset:384
    s_barrier
    s_lshl2_add_u32 s64, s49, s48
    s_lshl_b32 s64, s64, 13
    s_mul_i32 s63, s65, 1835008
    s_add_u32 s64, s64, s63
    s_add_u32 s64, s64, 917504
    v_bfe_u32 v136, v254, 2, 3
    v_min_u32 v136, 6, v136
    v_lshlrev_b32 v136, 17, v136
    v_and_b32 v135, 3, v254
    v_lshl_add_u32 v136, v135, 11, v136
    v_lshrrev_b32 v135, 5, v254
    v_lshl_add_u32 v136, v135, 10, v136
    buffer_load_dword v138, v136, s[32:35], s64 offen offset:384
    s_barrier
    v_add_u32 v134, 131072, v134
    v_subrev_u32 v135, 917504, v134
    v_min_u32 v134, v134, v135
    s_add_u32 s64, s4, 0
    s_mov_b32 exec_lo, 0xf7f7f7f7
    s_mov_b32 exec_hi, 0xf7f7f7f7
    buffer_load_dword v138, v134, s[32:35], s64 offen
    s_mov_b64 exec, -1
    s_barrier
    s_add_u32 s64, s4, 917504
    s_mov_b32 exec_lo, 0xf7f7f7f7
    s_mov_b32 exec_hi, 0xf7f7f7f7
    buffer_load_dword v138, v134, s[32:35], s64 offen
    s_mov_b64 exec, -1
    s_barrier
    s_branch L_COMMON
L_SPARE:
    s_lshl_b32 s71, s2, 2
    s_add_u32 s71, s71, s48
    s_lshl_b32 s71, s71, 9
    s_add_u32 s71, s71, 8912896
    s_lshl2_add_u32 s70, s2, s48
    s_lshl_b32 s70, s70, 10
    s_and_b32 s70, s70, 0x3c00
    s_add_u32 s70, s70, 10485760
    s_add_u32 m0, s56, 139264
    s_bfe_u32 s10, s58, 0x40000
    s_lshl_b32 s10, s10, 17
    s_add_u32 s10, s10, s69
    s_add_u32 s18, s10, 0
    buffer_load_dwordx4 v234, s[32:35], s18 offen lds
    buffer_load_dwordx4 v235, s[32:35], s18 offen offset:1024 lds
    s_add_u32 m0, s56, 24576
    s_add_u32 s19, s10, 65536
    buffer_load_dwordx4 v234, s[32:35], s19 offen lds
    buffer_load_dwordx4 v235, s[32:35], s19 offen offset:1024 lds
    s_add_u32 m0, s56, 0
    s_add_u32 s18, s10, 917504
    buffer_load_dwordx4 v234, s[32:35], s18 offen lds
    buffer_load_dwordx4 v235, s[32:35], s18 offen offset:1024 lds
    s_add_u32 m0, s56, 8192
    s_add_u32 s19, s10, 983040
    buffer_load_dwordx4 v234, s[32:35], s19 offen lds
    buffer_load_dwordx4 v235, s[32:35], s19 offen offset:1024 lds
    s_add_u32 m0, s56, 16384
    s_bfe_u32 s10, s58, 0x40004
    s_lshl_b32 s10, s10, 17
    s_add_u32 s10, s10, s69
    s_add_u32 s18, s10, 0
    buffer_load_dwordx4 v234, s[32:35], s18 offen lds
    buffer_load_dwordx4 v235, s[32:35], s18 offen offset:1024 lds
    s_add_u32 m0, s56, 32768
    s_add_u32 s19, s10, 65536
    buffer_load_dwordx4 v234, s[32:35], s19 offen lds
    buffer_load_dwordx4 v235, s[32:35], s19 offen offset:1024 lds
    s_add_u32 m0, s56, 40960
    s_add_u32 s18, s10, 917504
    buffer_load_dwordx4 v234, s[32:35], s18 offen lds
    buffer_load_dwordx4 v235, s[32:35], s18 offen offset:1024 lds
    s_add_u32 m0, s56, 49152
    s_add_u32 s19, s10, 983040
    buffer_load_dwordx4 v234, s[32:35], s19 offen lds
    buffer_load_dwordx4 v235, s[32:35], s19 offen offset:1024 lds
    s_add_u32 m0, s56, 57344
    s_bfe_u32 s10, s58, 0x40008
    s_lshl_b32 s10, s10, 17
    s_add_u32 s10, s10, s69
    s_add_u32 s18, s10, 0
    buffer_load_dwordx4 v234, s[32:35], s18 offen lds
    buffer_load_dwordx4 v235, s[32:35], s18 offen offset:1024 lds
    s_add_u32 m0, s56, 65536
    s_add_u32 s19, s10, 65536
    buffer_load_dwordx4 v234, s[32:35], s19 offen lds
    buffer_load_dwordx4 v235, s[32:35], s19 offen offset:1024 lds
    s_add_u32 m0, s56, 73728
    s_add_u32 s18, s10, 917504
    buffer_load_dwordx4 v234, s[32:35], s18 offen lds
    buffer_load_dwordx4 v235, s[32:35], s18 offen offset:1024 lds
    s_add_u32 m0, s56, 81920
    s_add_u32 s19, s10, 983040
    buffer_load_dwordx4 v234, s[32:35], s19 offen lds
    buffer_load_dwordx4 v235, s[32:35], s19 offen offset:1024 lds
    s_add_u32 m0, s56, 90112
    s_bfe_u32 s10, s58, 0x4000c
    s_lshl_b32 s10, s10, 17
    s_add_u32 s10, s10, s69
    s_add_u32 s18, s10, 0
    buffer_load_dwordx4 v234, s[32:35], s18 offen lds
    buffer_load_dwordx4 v235, s[32:35], s18 offen offset:1024 lds
    s_add_u32 m0, s56, 98304
    s_add_u32 s19, s10, 65536
    buffer_load_dwordx4 v234, s[32:35], s19 offen lds
    buffer_load_dwordx4 v235, s[32:35], s19 offen offset:1024 lds
    s_add_u32 m0, s56, 106496
    s_add_u32 s18, s10, 917504
    buffer_load_dwordx4 v234, s[32:35], s18 offen lds
    buffer_load_dwordx4 v235, s[32:35], s18 offen offset:1024 lds
    s_add_u32 m0, s56, 114688
    s_add_u32 s19, s10, 983040
    buffer_load_dwordx4 v234, s[32:35], s19 offen lds
    buffer_load_dwordx4 v235, s[32:35], s19 offen offset:1024 lds
    s_add_u32 m0, s56, 122880
    s_bfe_u32 s10, s58, 0x40010
    s_lshl_b32 s10, s10, 17
    s_add_u32 s10, s10, s69
    s_add_u32 s18, s10, 0
    buffer_load_dwordx4 v234, s[32:35], s18 offen lds
    buffer_load_dwordx4 v235, s[32:35], s18 offen offset:1024 lds
    s_add_u32 m0, s56, 131072
    s_add_u32 s19, s10, 65536
    buffer_load_dwordx4 v234, s[32:35], s19 offen lds
    buffer_load_dwordx4 v235, s[32:35], s19 offen offset:1024 lds
    s_add_u32 m0, s56, 147456
    s_add_u32 s18, s10, 917504
    buffer_load_dwordx4 v234, s[32:35], s18 offen lds
    buffer_load_dwordx4 v235, s[32:35], s18 offen offset:1024 lds
    s_add_u32 m0, s56, 155648
    s_add_u32 s19, s10, 983040
    buffer_load_dwordx4 v234, s[32:35], s19 offen lds
    buffer_load_dwordx4 v235, s[32:35], s19 offen offset:1024 lds
    s_waitcnt vmcnt(24)
    ds_read_b64_tr_b16 v[176:177], v240 offset:8192
    ds_read_b64_tr_b16 v[178:179], v240 offset:9216
    ds_read_b64_tr_b16 v[180:181], v241 offset:8192
    ds_read_b64_tr_b16 v[182:183], v241 offset:9216
    ds_read_b64_tr_b16 v[184:185], v236 offset:24576
    ds_read_b64_tr_b16 v[186:187], v236 offset:25600
    ds_read_b64_tr_b16 v[188:189], v237 offset:24576
    ds_read_b64_tr_b16 v[190:191], v237 offset:25600
    ds_read_b64_tr_b16 v[192:193], v236 offset:0
    ds_read_b64_tr_b16 v[194:195], v236 offset:1024
    ds_read_b64_tr_b16 v[196:197], v237 offset:0
    ds_read_b64_tr_b16 v[198:199], v237 offset:1024
    ds_read_b64_tr_b16 v[200:201], v236 offset:8192
    ds_read_b64_tr_b16 v[202:203], v236 offset:9216
    ds_read_b64_tr_b16 v[204:205], v237 offset:8192
    ds_read_b64_tr_b16 v[206:207], v237 offset:9216
    ds_read_b64_tr_b16 v[208:209], v236 offset:16384
    ds_read_b64_tr_b16 v[210:211], v236 offset:17408
    ds_read_b64_tr_b16 v[212:213], v237 offset:16384
    ds_read_b64_tr_b16 v[214:215], v237 offset:17408
    ds_read_b64_tr_b16 v[216:217], v236 offset:32768
    ds_read_b64_tr_b16 v[218:219], v236 offset:33792
    ds_read_b64_tr_b16 v[220:221], v237 offset:32768
    ds_read_b64_tr_b16 v[222:223], v237 offset:33792
    ds_read_b64_tr_b16 a[0:1], v236 offset:40960
    ds_read_b64_tr_b16 a[2:3], v236 offset:41984
    ds_read_b64_tr_b16 a[4:5], v237 offset:40960
    ds_read_b64_tr_b16 a[6:7], v237 offset:41984
    ds_read_b64_tr_b16 a[8:9], v236 offset:49152
    ds_read_b64_tr_b16 a[10:11], v236 offset:50176
    ds_read_b64_tr_b16 a[12:13], v237 offset:49152
    ds_read_b64_tr_b16 a[14:15], v237 offset:50176
    s_waitcnt lgkmcnt(0)
    s_add_u32 m0, s56, 0
    s_bfe_u32 s10, s58, 0x40014
    s_lshl_b32 s10, s10, 17
    s_add_u32 s10, s10, s69
    s_add_u32 s18, s10, 0
    buffer_load_dwordx4 v234, s[32:35], s18 offen lds
    buffer_load_dwordx4 v235, s[32:35], s18 offen offset:1024 lds
    s_add_u32 m0, s56, 8192
    s_add_u32 s19, s10, 65536
    buffer_load_dwordx4 v234, s[32:35], s19 offen lds
    buffer_load_dwordx4 v235, s[32:35], s19 offen offset:1024 lds
    s_add_u32 m0, s56, 16384
    s_add_u32 s18, s10, 917504
    buffer_load_dwordx4 v234, s[32:35], s18 offen lds
    buffer_load_dwordx4 v235, s[32:35], s18 offen offset:1024 lds
    s_add_u32 m0, s56, 32768
    s_add_u32 s19, s10, 983040
    buffer_load_dwordx4 v234, s[32:35], s19 offen lds
    buffer_load_dwordx4 v235, s[32:35], s19 offen offset:1024 lds
    s_add_u32 m0, s56, 40960
    s_bfe_u32 s10, s58, 0x40018
    s_lshl_b32 s10, s10, 17
    s_add_u32 s10, s10, s69
    s_add_u32 s18, s10, 0
    buffer_load_dwordx4 v234, s[32:35], s18 offen lds
    buffer_load_dwordx4 v235, s[32:35], s18 offen offset:1024 lds
    s_add_u32 m0, s56, 49152
    s_add_u32 s19, s10, 65536
    buffer_load_dwordx4 v234, s[32:35], s19 offen lds
    buffer_load_dwordx4 v235, s[32:35], s19 offen offset:1024 lds
    s_add_u32 m0, s56, 139264
    s_add_u32 s18, s10, 917504
    buffer_load_dwordx4 v234, s[32:35], s18 offen lds
    buffer_load_dwordx4 v235, s[32:35], s18 offen offset:1024 lds
    s_add_u32 m0, s56, 24576
    s_add_u32 s19, s10, 983040
    buffer_load_dwordx4 v234, s[32:35], s19 offen lds
    buffer_load_dwordx4 v235, s[32:35], s19 offen offset:1024 lds
    buffer_load_dwordx2 v[248:249], off, s[40:43], 0 sc1
    buffer_load_dwordx2 v[232:233], v253, s[44:47], s72 offen offset:0 sc1
    s_lshl2_add_u32 s61, s86, s48
    s_mov_b64 exec, 0
    s_cmp_eq_u32 s61, 0
    s_cbranch_scc1 L_D2_0
    s_cmp_eq_u32 s61, 1
    s_cbranch_scc1 L_D2_1
    s_cmp_eq_u32 s61, 2
    s_cbranch_scc1 L_D2_2
    s_cmp_eq_u32 s61, 3
    s_cbranch_scc1 L_D2_4
    s_cmp_eq_u32 s61, 4
    s_cbranch_scc1 L_D2_5
    s_cmp_eq_u32 s61, 5
    s_cbranch_scc1 L_D2_7
    s_cmp_eq_u32 s61, 6
    s_cbranch_scc1 L_D2_8
    s_cmp_eq_u32 s61, 7
    s_cbranch_scc1 L_D2_10
    s_cmp_eq_u32 s61, 8
    s_cbranch_scc1 L_D2_11
    s_cmp_eq_u32 s61, 9
    s_cbranch_scc1 L_D2_12
    s_cmp_eq_u32 s61, 10
    s_cbranch_scc1 L_D2_14
    s_cmp_eq_u32 s61, 11
    s_cbranch_scc1 L_D2_15
    s_cmp_eq_u32 s61, 12
    s_cbranch_scc1 L_D2_17
    s_cmp_eq_u32 s61, 13
    s_cbranch_scc1 L_D2_18
    s_cmp_eq_u32 s61, 14
    s_cbranch_scc1 L_D2_20
    s_cmp_eq_u32 s61, 15
    s_cbranch_scc1 L_D2_21
L_DW2:
    s_mov_b64 exec, -1
    s_waitcnt vmcnt(34)
    ds_read_b64_tr_b16 a[16:17], v236 offset:57344
    ds_read_b64_tr_b16 a[18:19], v236 offset:58368
    ds_read_b64_tr_b16 a[20:21], v237 offset:57344
    ds_read_b64_tr_b16 a[22:23], v237 offset:58368
    ds_read_b64_tr_b16 a[24:25], v238 offset:0
    ds_read_b64_tr_b16 a[26:27], v238 offset:1024
    ds_read_b64_tr_b16 a[28:29], v239 offset:0
    ds_read_b64_tr_b16 a[30:31], v239 offset:1024
    ds_read_b64_tr_b16 a[32:33], v238 offset:8192
    ds_read_b64_tr_b16 a[34:35], v238 offset:9216
    ds_read_b64_tr_b16 a[36:37], v239 offset:8192
    ds_read_b64_tr_b16 a[38:39], v239 offset:9216
    ds_read_b64_tr_b16 a[40:41], v238 offset:16384
    ds_read_b64_tr_b16 a[42:43], v238 offset:17408
    ds_read_b64_tr_b16 a[44:45], v239 offset:16384
    ds_read_b64_tr_b16 a[46:47], v239 offset:17408
    s_waitcnt vmcnt(26)
    ds_read_b64_tr_b16 a[48:49], v238 offset:24576
    ds_read_b64_tr_b16 a[50:51], v238 offset:25600
    ds_read_b64_tr_b16 a[52:53], v239 offset:24576
    ds_read_b64_tr_b16 a[54:55], v239 offset:25600
    ds_read_b64_tr_b16 a[56:57], v238 offset:32768
    ds_read_b64_tr_b16 a[58:59], v238 offset:33792
    ds_read_b64_tr_b16 a[60:61], v239 offset:32768
    ds_read_b64_tr_b16 a[62:63], v239 offset:33792
    ds_read_b64_tr_b16 a[64:65], v238 offset:40960
    ds_read_b64_tr_b16 a[66:67], v238 offset:41984
    ds_read_b64_tr_b16 a[68:69], v239 offset:40960
    ds_read_b64_tr_b16 a[70:71], v239 offset:41984
    ds_read_b64_tr_b16 a[72:73], v238 offset:49152
    ds_read_b64_tr_b16 a[74:75], v238 offset:50176
    ds_read_b64_tr_b16 a[76:77], v239 offset:49152
    ds_read_b64_tr_b16 a[78:79], v239 offset:50176
    s_waitcnt vmcnt(18)
    ds_read_b64_tr_b16 a[80:81], v238 offset:57344
    ds_read_b64_tr_b16 a[82:83], v238 offset:58368
    ds_read_b64_tr_b16 a[84:85], v239 offset:57344
    ds_read_b64_tr_b16 a[86:87], v239 offset:58368
    ds_read_b64_tr_b16 a[88:89], v240 offset:0
    ds_read_b64_tr_b16 a[90:91], v240 offset:1024
    ds_read_b64_tr_b16 a[92:93], v241 offset:0
    ds_read_b64_tr_b16 a[94:95], v241 offset:1024
    ds_read_b64_tr_b16 a[96:97], v240 offset:16384
    ds_read_b64_tr_b16 a[98:99], v240 offset:17408
    ds_read_b64_tr_b16 a[100:101], v241 offset:16384
    ds_read_b64_tr_b16 a[102:103], v241 offset:17408
    ds_read_b64_tr_b16 a[104:105], v240 offset:24576
    ds_read_b64_tr_b16 a[106:107], v240 offset:25600
    ds_read_b64_tr_b16 a[108:109], v241 offset:24576
    ds_read_b64_tr_b16 a[110:111], v241 offset:25600
    s_waitcnt vmcnt(10)
    ds_read_b64_tr_b16 a[112:113], v236 offset:0
    ds_read_b64_tr_b16 a[114:115], v236 offset:1024
    ds_read_b64_tr_b16 a[116:117], v237 offset:0
    ds_read_b64_tr_b16 a[118:119], v237 offset:1024
    ds_read_b64_tr_b16 a[120:121], v236 offset:8192
    ds_read_b64_tr_b16 a[122:123], v236 offset:9216
    ds_read_b64_tr_b16 a[124:125], v237 offset:8192
    ds_read_b64_tr_b16 a[126:127], v237 offset:9216
    ds_read_b64_tr_b16 v[0:1], v236 offset:16384
    ds_read_b64_tr_b16 v[2:3], v236 offset:17408
    ds_read_b64_tr_b16 v[4:5], v237 offset:16384
    ds_read_b64_tr_b16 v[6:7], v237 offset:17408
    ds_read_b64_tr_b16 v[8:9], v236 offset:32768
    ds_read_b64_tr_b16 v[10:11], v236 offset:33792
    ds_read_b64_tr_b16 v[12:13], v237 offset:32768
    ds_read_b64_tr_b16 v[14:15], v237 offset:33792
    s_waitcnt vmcnt(2)
    ds_read_b64_tr_b16 v[16:17], v236 offset:40960
    ds_read_b64_tr_b16 v[18:19], v236 offset:41984
    ds_read_b64_tr_b16 v[20:21], v237 offset:40960
    ds_read_b64_tr_b16 v[22:23], v237 offset:41984
    ds_read_b64_tr_b16 v[24:25], v236 offset:49152
    ds_read_b64_tr_b16 v[26:27], v236 offset:50176
    ds_read_b64_tr_b16 v[28:29], v237 offset:49152
    ds_read_b64_tr_b16 v[30:31], v237 offset:50176
    ds_read_b64_tr_b16 v[32:33], v240 offset:8192
    ds_read_b64_tr_b16 v[34:35], v240 offset:9216
    ds_read_b64_tr_b16 v[36:37], v241 offset:8192
    ds_read_b64_tr_b16 v[38:39], v241 offset:9216
    ds_read_b64_tr_b16 v[40:41], v236 offset:24576
    ds_read_b64_tr_b16 v[42:43], v236 offset:25600
    ds_read_b64_tr_b16 v[44:45], v237 offset:24576
    ds_read_b64_tr_b16 v[46:47], v237 offset:25600
    v_add_u32 v228, 65536, v252
    v_add_u32 v229, 131072, v252
    s_mov_b32 s93, 40000
    s_branch L_SN0
L_SN:
    buffer_load_dwordx2 v[248:249], off, s[40:43], 0 sc1
L_SN0:
    s_waitcnt vmcnt(0) lgkmcnt(0)
    v_readfirstlane_b32 s96, v248
    v_readfirstlane_b32 s97, v249
    s_sub_u32 s93, s93, 1
    s_cmp_eq_u32 s93, 0
    s_cbranch_scc1 L_SN1
    s_cmp_eq_u32 s97, 0
    s_cbranch_scc1 L_SN
L_SN1:
    s_and_b32 s61, s2, 1
    s_xor_b32 s61, s61, 1
    s_lshl_b32 s61, s61, 1
    s_cmp_lg_u32 s61, s48
    s_cbranch_scc1 L_GD
    s_mov_b32 s93, 4000
L_GT:
    buffer_load_dwordx2 v[232:233], v253, s[44:47], s72 offen offset:0 sc1
    s_waitcnt vmcnt(0)
    v_cmp_ne_u64 vcc, v[232:233], s[96:97]
    s_sub_u32 s93, s93, 1
    s_cbranch_vccz L_GD
    s_cmp_eq_u32 s93, 0
    s_cbranch_scc1 L_GD
    s_sleep 16
    s_branch L_GT
L_GD:
    s_barrier
    s_mov_b32 s68, 9437184
    v_mov_b32 v250, 0
    v_mov_b32 v251, 0
    s_branch L_JOIN
.section .rodata,"a"
.p2align 6
.amdhsa_kernel standalone__swiglu_ffn__sampling_kernel
  .amdhsa_next_free_vgpr 512
  .amdhsa_next_free_sgpr 102
  .amdhsa_accum_offset 256
  .amdhsa_group_segment_fixed_size 0
  .amdhsa_kernarg_size 56
  .amdhsa_user_sgpr_count 2
  .amdhsa_user_sgpr_kernarg_segment_ptr 1
  .amdhsa_system_sgpr_workgroup_id_x 1
  .amdhsa_float_denorm_mode_32 3
  .amdhsa_float_denorm_mode_16_64 3
.end_amdhsa_kernel
```
